```python
import torch

def _softmax(x, axis=-1):
    return torch.softmax(x, dim=axis)
def _gelu(x):
    return torch.nn.functional.gelu(x, approximate="tanh")
def _silu(x):
    return torch.nn.functional.silu(x)
def _sigmoid(x):
    return torch.sigmoid(x)
def _layernorm(x, axis=-1, eps=1e-5):
    m = x.mean(dim=axis, keepdim=True)
    v = x.var(dim=axis, keepdim=True, unbiased=False)
    return (x - m) / torch.sqrt(v + eps)
def _scatter_add(tgt, idx, src, axis=0):
    return tgt.clone().index_add_(axis, idx, src)
def _segment_sum(src, seg, n):
    out = torch.zeros((n,) + src.shape[1:], dtype=src.dtype)
    return out.index_add_(0, seg, src)
def _pad(x, pw):
    flat = tuple(v for pair in reversed(pw) for v in pair)
    return torch.nn.functional.pad(x, flat)

kernel_name = 'sequential_preLN__gqa_block_cached__glu_gated_geglu__decode'

def setup_inputs():

    _w = (lambda a: (lambda t: t.to(torch.bfloat16) if t.is_floating_point() else t)(torch.as_tensor(a)))
    def _A_setup():
        B, Sq, D = 1, 1, 640
        Hq, Hkv, Sk, Dh = 32, 32, 4096, 128
        assert Hq % Hkv == 0, (Hq, Hkv)
        return {
            "x": _w((lambda *s: torch.randn(*s, dtype=torch.bfloat16) * 0.05)(B, Sq, D)),
            "k_cache": _w((lambda *s: torch.randn(*s, dtype=torch.bfloat16) * 1.6)(B, Hkv, Sk, Dh)),
            "v_cache": _w((lambda *s: torch.randn(*s, dtype=torch.bfloat16) * 0.8)(B, Hkv, Sk, Dh)),
            "wq": _w((lambda *s: torch.randn(*s, dtype=torch.bfloat16) * 1.6)(D, Hq * Dh) * (D ** -0.5)),
            "wo": _w((lambda *s: torch.randn(*s, dtype=torch.bfloat16) * 0.8)(Hq * Dh, D) * ((Hq * Dh) ** -0.5)),
        }
    _A_in = _A_setup()

    def _B_setup():
        B, S, Dm, Df = 1, 1, 640, 1728
        return {
            "x": _w((lambda *s: torch.randn(*s, dtype=torch.bfloat16) * 0.05)(B, S, Dm)),
            "w_gate": _w((lambda *s: torch.randn(*s, dtype=torch.bfloat16) * 0.4)(Dm, Df) * (Dm ** -0.5)),
            "w_up": _w((lambda *s: torch.randn(*s, dtype=torch.bfloat16) * 0.4)(Dm, Df) * (Dm ** -0.5)),
            "w_down": _w((lambda *s: torch.randn(*s, dtype=torch.bfloat16) * 0.4)(Df, Dm) * (Df ** -0.5)),
        }
    _B_in = _B_setup()

    return {
        "A_x": _A_in["x"],
        "A_k_cache": _A_in["k_cache"],
        "A_v_cache": _A_in["v_cache"],
        "A_wq": _A_in["wq"],
        "A_wo": _A_in["wo"],
        "B_x": _B_in["x"],
        "B_w_gate": _B_in["w_gate"],
        "B_w_up": _B_in["w_up"],
        "B_w_down": _B_in["w_down"],
    }

def reference(A_x, A_k_cache, A_v_cache, A_wq, A_wo, B_x, B_w_gate, B_w_up, B_w_down):
    def _A_ref(x, k_cache, v_cache, wq, wo):
        B, Sq, D = x.shape
        Hq, Dh = 32, 128
        Hkv = k_cache.shape[1]
        rep = Hq // Hkv
        q = (lambda x, *d: x.permute(*d))((x @ wq).reshape(B, Sq, Hq, Dh), 0, 2, 1, 3)
        k = (lambda x, n, axis: torch.repeat_interleave(x, n, dim=axis))(k_cache, rep, axis=1)
        v = (lambda x, n, axis: torch.repeat_interleave(x, n, dim=axis))(v_cache, rep, axis=1)
        scores = torch.einsum("bhqd,bhkd->bhqk", q, k) * (Dh ** -0.5)
        p = _softmax(scores, axis=-1)
        o = torch.einsum("bhqk,bhkd->bhqd", p, v)
        return (lambda x, *d: x.permute(*d))(o, 0, 2, 1, 3).reshape(B, Sq, Hq * Dh) @ wo

    def _B_ref(x, w_gate, w_up, w_down):
        g = torch.einsum("bsd,df->bsf", x, w_gate)
        u = torch.einsum("bsd,df->bsf", x, w_up)
        h = _gelu(g) * u
        return torch.einsum("bsf,fd->bsd", h, w_down)

    x = A_x
    h = x + _A_ref(_layernorm(x, axis=-1), A_k_cache, A_v_cache, A_wq, A_wo)
    h2 = h + _B_ref(_layernorm(h, axis=-1), B_w_gate, B_w_up, B_w_down)
    return h2
```

```asm
; @launch grid=(256,1,1) block=(512,1,1) lds=25856
.amdgcn_target "amdgcn-amd-amdhsa--gfx950"
.text
.globl sequential_preLN__gqa_block_cached__glu_gated_geglu__decode_kernel
.p2align 8
.type sequential_preLN__gqa_block_cached__glu_gated_geglu__decode_kernel,@function
sequential_preLN__gqa_block_cached__glu_gated_geglu__decode_kernel:
    s_cmp_ge_u32 s2, 256
    s_cbranch_scc1 L_end
    s_load_dwordx16 s[4:19], s[0:1], 0
    s_load_dwordx8 s[20:27], s[0:1], 64
    v_mov_b32 v32, 0
    v_mov_b32 v33, 0
    v_lshrrev_b32 v10, 6, v0
    v_and_b32 v1, 63, v0
    ds_write_b64 v32, v[32:33] offset:4352
    s_mov_b32 s3, 0xffffff00
    s_and_b32 s76, s2, 7
    s_lshr_b32 s77, s2, 3
    v_readfirstlane_b32 s64, v10
    s_and_b32 s78, s77, 3
    s_lshl_b32 s65, s76, 2
    s_add_u32 s65, s65, s78
    s_lshr_b32 s66, s77, 2
    s_lshl_b32 s67, s65, 3
    s_add_u32 s67, s67, s66
    s_sub_u32 s68, s77, 0
    s_cmp_lt_u32 s68, 10
    s_cselect_b32 s68, s68, -1
    s_sub_u32 s77, s77, 10
    s_lshr_b32 s78, s77, 1
    s_lshl_b32 s78, s78, 3
    s_add_u32 s78, s78, s76
    s_and_b32 s79, s77, 1
    s_lshl_b32 s69, s78, 1
    s_add_u32 s69, s69, s79
    s_cmp_lt_u32 s78, 27
    s_cselect_b32 s69, s69, -1
    s_add_u32 s70, s65, 0
    s_and_b32 s70, s70, 31
    s_lshl_b32 s70, s70, 20
    s_lshl_b32 s78, s66, 17
    s_add_u32 s70, s70, s78
    s_lshl_b32 s78, s64, 14
    s_add_u32 s70, s70, s78
    s_add_u32 s71, s70, 4096
    s_add_u32 s72, s70, 8192
    s_add_u32 s73, s70, 12288
    s_lshl_b32 s74, s76, 3
    s_add_u32 s74, s74, s64
    s_mul_i32 s74, s74, 81920
    s_lshl_b32 s78, s68, 7
    s_add_u32 s74, s74, s78
    s_cmp_eq_u32 s68, -1
    s_cselect_b32 s74, 0x10000000, s74
    s_mov_b32 s80, 0x00ff00ff
    s_mov_b32 s81, 0x00ff00ff
    s_mov_b32 s82, -1
    s_mov_b32 s83, 0
    s_mov_b32 s87, 0x3fb8aa3b
    s_mov_b32 s88, 0x3db504f3
    s_mov_b32 s89, 0xffff0000
    v_lshlrev_b32 v2, 4, v1
    v_lshrrev_b32 v10, 4, v1
    v_and_b32 v11, 15, v1
    v_mul_u32_u24 v12, 20, v1
    v_lshlrev_b32 v13, 4, v11
    v_lshl_add_u32 v14, v10, 13, v13
    v_lshlrev_b32 v15, 1, v10
    v_and_b32 v13, 3, v1
    v_lshlrev_b32 v3, 8, v13
    v_bfe_u32 v6, v1, 2, 2
    v_lshl_add_u32 v3, v6, 6, v3
    v_lshl_add_u32 v3, v10, 4, v3
    v_bfe_u32 v6, v1, 4, 1
    v_bfe_u32 v7, v1, 5, 1
    v_lshlrev_b32 v47, 4, v11
    v_lshl_add_u32 v47, v6, 9, v47
    v_lshl_add_u32 v47, v7, 8, v47
    v_lshl_add_u32 v6, v6, 1, v7
    v_bfe_u32 v7, v1, 3, 1
    v_lshl_add_u32 v6, v7, 5, v6
    v_mul_u32_u24 v4, 1280, v6
    v_and_b32 v6, 7, v1
    v_lshl_add_u32 v4, v6, 4, v4
    v_lshlrev_b32 v5, 6, v1
    v_mov_b32 v6, 0x10000000
    v_cmp_gt_u32 vcc, 40, v1
    s_nop 1
    v_cndmask_b32 v5, v6, v5, vcc
    s_mul_i32 s76, s66, 80
    s_mul_i32 s77, s64, 20
    s_add_u32 s76, s76, s77
    s_lshl_b32 s77, s76, 13
    s_lshl_b32 s78, s65, 8
    s_add_u32 s77, s77, s78
    s_lshl_b32 s76, s76, 1
    s_waitcnt lgkmcnt(0)
    s_load_dword s55, s[26:27], 0xf008
    s_setprio 3
    s_cmp_ge_u32 s64, 4
    s_cbranch_scc1 L_sw
    s_mov_b32 s28, s4
    s_mov_b32 s29, s5
    s_mov_b32 s30, 0x500
    s_mov_b32 s31, 0x20000
    s_mov_b32 s40, s10
    s_mov_b32 s41, s11
    s_mov_b32 s42, 0x500000
    s_mov_b32 s43, 0x20000
    buffer_load_dwordx4 v[124:127], v12, s[28:31], 0 offen
    buffer_load_dword v128, v12, s[28:31], 0 offen offset:16
    buffer_load_ushort v129, v15, s[28:31], s76 offen offset:0
    buffer_load_ushort v130, v15, s[28:31], s76 offen offset:8
    buffer_load_ushort v131, v15, s[28:31], s76 offen offset:16
    buffer_load_ushort v132, v15, s[28:31], s76 offen offset:24
    buffer_load_ushort v133, v15, s[28:31], s76 offen offset:32
    buffer_load_dwordx4 v[136:139], v14, s[40:43], s77 offen nt
    s_add_u32 s77, s77, 32768
    buffer_load_dwordx4 v[140:143], v14, s[40:43], s77 offen nt
    s_add_u32 s77, s77, 32768
    buffer_load_dwordx4 v[144:147], v14, s[40:43], s77 offen nt
    s_add_u32 s77, s77, 32768
    buffer_load_dwordx4 v[148:151], v14, s[40:43], s77 offen nt
    s_add_u32 s77, s77, 32768
    buffer_load_dwordx4 v[152:155], v14, s[40:43], s77 offen nt
    s_barrier
    s_mov_b32 s32, s6
    s_mov_b32 s33, s7
    s_mov_b32 s34, 0x2000000
    s_mov_b32 s35, 0x20000
    s_mov_b32 s44, s12
    s_mov_b32 s45, s13
    s_mov_b32 s46, 0x500000
    s_mov_b32 s47, 0x20000
    s_mov_b32 s36, s8
    s_mov_b32 s37, s9
    s_mov_b32 s38, 0x2000000
    s_mov_b32 s39, 0x20000
    s_mov_b32 s48, s26
    s_mov_b32 s49, s27
    s_mov_b32 s50, 0x10000000
    s_mov_b32 s51, 0x20000
    s_mov_b32 s56, s22
    s_mov_b32 s57, s23
    s_mov_b32 s58, 0x500
    s_mov_b32 s59, 0x20000
    s_mov_b32 s60, s20
    s_mov_b32 s61, s21
    s_mov_b32 s62, 0x21c000
    s_mov_b32 s63, 0x20000
    v_and_b32 v10, 1, v1
    v_lshlrev_b32 v10, 4, v10
    v_mov_b32 v11, 0xffff
    v_lshlrev_b32 v10, v10, v11
    v_bfe_u32 v11, v1, 1, 2
    v_cmp_eq_u32 vcc, 0, v11
    s_nop 1
    v_cndmask_b32 v6, 0, v10, vcc
    v_cmp_eq_u32 vcc, 1, v11
    s_nop 1
    v_cndmask_b32 v7, 0, v10, vcc
    v_cmp_eq_u32 vcc, 2, v11
    s_nop 1
    v_cndmask_b32 v8, 0, v10, vcc
    v_cmp_eq_u32 vcc, 3, v11
    s_nop 1
    v_cndmask_b32 v9, 0, v10, vcc
    v_lshrrev_b32 v10, 4, v1
    v_and_b32 v11, 15, v1
    v_lshlrev_b32 v12, 5, v11
    v_lshl_add_u32 v12, v10, 4, v12
    s_lshl_b32 s76, s64, 9
    v_add_u32 v13, s76, v12
    v_mov_b32 v14, 0
    v_mov_b32 v15, 1
    s_waitcnt vmcnt(5)
    v_lshlrev_b32 v16, 16, v124
    v_and_b32 v17, s89, v124
    v_lshlrev_b32 v18, 16, v125
    v_and_b32 v19, s89, v125
    v_lshlrev_b32 v20, 16, v126
    v_and_b32 v21, s89, v126
    v_lshlrev_b32 v22, 16, v127
    v_and_b32 v23, s89, v127
    v_lshlrev_b32 v24, 16, v128
    v_and_b32 v25, s89, v128
    v_add_f32 v26, v16, v17
    v_add_f32 v27, v18, v19
    v_add_f32 v26, v26, v20
    v_add_f32 v27, v27, v21
    v_add_f32 v26, v26, v22
    v_add_f32 v27, v27, v23
    v_add_f32 v26, v26, v24
    v_add_f32 v27, v27, v25
    v_add_f32 v26, v26, v27
    s_nop 1
    v_add_f32_dpp v26, v26, v26 row_ror:8 row_mask:0xf bank_mask:0xf
    s_nop 1
    v_add_f32_dpp v26, v26, v26 row_ror:4 row_mask:0xf bank_mask:0xf
    s_nop 1
    v_add_f32_dpp v26, v26, v26 row_ror:2 row_mask:0xf bank_mask:0xf
    s_nop 1
    v_add_f32_dpp v26, v26, v26 row_ror:1 row_mask:0xf bank_mask:0xf
    v_mov_b32 v28, v26
    s_nop 1
    v_permlane16_swap_b32 v26, v28
    v_add_f32 v26, v26, v28
    v_mov_b32 v28, v26
    s_nop 1
    v_permlane32_swap_b32 v26, v28
    v_add_f32 v26, v26, v28
    v_mul_f32 v26, 0x3acccccd, v26
    v_sub_f32 v28, v16, v26
    v_mul_f32 v27, v28, v28
    v_sub_f32 v28, v17, v26
    v_fmac_f32 v27, v28, v28
    v_sub_f32 v28, v18, v26
    v_fmac_f32 v27, v28, v28
    v_sub_f32 v28, v19, v26
    v_fmac_f32 v27, v28, v28
    v_sub_f32 v28, v20, v26
    v_fmac_f32 v27, v28, v28
    v_sub_f32 v28, v21, v26
    v_fmac_f32 v27, v28, v28
    v_sub_f32 v28, v22, v26
    v_fmac_f32 v27, v28, v28
    v_sub_f32 v28, v23, v26
    v_fmac_f32 v27, v28, v28
    v_sub_f32 v28, v24, v26
    v_fmac_f32 v27, v28, v28
    v_sub_f32 v28, v25, v26
    v_fmac_f32 v27, v28, v28
    s_nop 1
    v_add_f32_dpp v27, v27, v27 row_ror:8 row_mask:0xf bank_mask:0xf
    s_nop 1
    v_add_f32_dpp v27, v27, v27 row_ror:4 row_mask:0xf bank_mask:0xf
    s_nop 1
    v_add_f32_dpp v27, v27, v27 row_ror:2 row_mask:0xf bank_mask:0xf
    s_nop 1
    v_add_f32_dpp v27, v27, v27 row_ror:1 row_mask:0xf bank_mask:0xf
    v_mov_b32 v28, v27
    s_nop 1
    v_permlane16_swap_b32 v27, v28
    v_add_f32 v27, v27, v28
    v_mov_b32 v28, v27
    s_nop 1
    v_permlane32_swap_b32 v27, v28
    v_add_f32 v27, v27, v28
    v_mul_f32 v27, 0x3acccccd, v27
    v_cvt_pk_bf16_f32 v27, 0, v27
    v_add_f32 v27, 0x3727c5ac, v27
    v_cvt_pk_bf16_f32 v27, 0, v27
    v_sqrt_f32 v27, v27
    v_cvt_pk_bf16_f32 v26, 0, v26
    v_cvt_pk_bf16_f32 v27, 0, v27
    v_rcp_f32 v27, v27
    v_lshlrev_b32 v129, 16, v129
    v_sub_f32 v129, v129, v26
    v_lshlrev_b32 v130, 16, v130
    v_sub_f32 v130, v130, v26
    v_lshlrev_b32 v131, 16, v131
    v_sub_f32 v131, v131, v26
    v_lshlrev_b32 v132, 16, v132
    v_sub_f32 v132, v132, v26
    v_lshlrev_b32 v133, 16, v133
    v_sub_f32 v133, v133, v26
    v_cvt_pk_bf16_f32 v129, 0, v129
    v_cvt_pk_bf16_f32 v130, 0, v130
    v_cvt_pk_bf16_f32 v131, 0, v131
    v_cvt_pk_bf16_f32 v132, 0, v132
    v_cvt_pk_bf16_f32 v133, 0, v133
    v_mul_f32 v129, v129, v27
    v_cvt_pk_bf16_f32 v129, v129, v129
    v_mul_f32 v130, v130, v27
    v_cvt_pk_bf16_f32 v130, v130, v130
    v_mul_f32 v131, v131, v27
    v_cvt_pk_bf16_f32 v131, v131, v131
    v_mul_f32 v132, v132, v27
    v_cvt_pk_bf16_f32 v132, v132, v132
    v_mul_f32 v133, v133, v27
    v_cvt_pk_bf16_f32 v133, v133, v133
    v_and_b32 v156, v129, v6
    v_and_b32 v157, v129, v7
    v_and_b32 v158, v129, v8
    v_and_b32 v159, v129, v9
    s_waitcnt vmcnt(4)
    s_nop 0
    v_mfma_f32_16x16x32_bf16 v[32:35], v[156:159], v[136:139], 0
    v_and_b32 v160, v130, v6
    v_and_b32 v161, v130, v7
    v_and_b32 v162, v130, v8
    v_and_b32 v163, v130, v9
    s_waitcnt vmcnt(3)
    s_nop 0
    v_mfma_f32_16x16x32_bf16 v[32:35], v[160:163], v[140:143], v[32:35]
    v_and_b32 v164, v131, v6
    v_and_b32 v165, v131, v7
    v_and_b32 v166, v131, v8
    v_and_b32 v167, v131, v9
    s_waitcnt vmcnt(2)
    s_nop 0
    v_mfma_f32_16x16x32_bf16 v[32:35], v[164:167], v[144:147], v[32:35]
    v_and_b32 v168, v132, v6
    v_and_b32 v169, v132, v7
    v_and_b32 v170, v132, v8
    v_and_b32 v171, v132, v9
    s_waitcnt vmcnt(1)
    s_nop 0
    v_mfma_f32_16x16x32_bf16 v[32:35], v[168:171], v[148:151], v[32:35]
    v_and_b32 v172, v133, v6
    v_and_b32 v173, v133, v7
    v_and_b32 v174, v133, v8
    v_and_b32 v175, v133, v9
    s_waitcnt vmcnt(0)
    s_nop 0
    v_mfma_f32_16x16x32_bf16 v[32:35], v[172:175], v[152:155], v[32:35]
    s_mov_b64 exec, s[82:83]
    s_nop 6
    ds_write_b128 v13, v[32:35] offset:0
    s_mov_b64 exec, 1
    s_cmp_eq_u32 s64, 0
    s_cbranch_scc1 L_w0
    ds_add_u32 v14, v15 offset:4356
    s_mov_b64 exec, -1
    s_branch L_w0c
L_sw:
    s_mov_b32 s32, s6
    s_mov_b32 s33, s7
    s_mov_b32 s34, 0x2000000
    s_mov_b32 s35, 0x20000
    s_mov_b32 s44, s12
    s_mov_b32 s45, s13
    s_mov_b32 s46, 0x500000
    s_mov_b32 s47, 0x20000
    s_mov_b32 s36, s8
    s_mov_b32 s37, s9
    s_mov_b32 s38, 0x2000000
    s_mov_b32 s39, 0x20000
    s_setprio 2
    s_barrier
    buffer_load_dwordx4 v[48:51], v3, s[32:35], s70 offen offset:0 nt
    buffer_load_dwordx4 v[52:55], v3, s[32:35], s70 offen offset:1024 nt
    buffer_load_dwordx4 v[56:59], v3, s[32:35], s70 offen offset:2048 nt
    buffer_load_dwordx4 v[60:63], v3, s[32:35], s70 offen offset:3072 nt
    buffer_load_dwordx4 v[64:67], v3, s[32:35], s71 offen offset:0 nt
    buffer_load_dwordx4 v[68:71], v3, s[32:35], s71 offen offset:1024 nt
    s_mov_b32 s48, s26
    s_mov_b32 s49, s27
    s_mov_b32 s50, 0x10000000
    s_mov_b32 s51, 0x20000
    s_mov_b32 s28, s4
    s_mov_b32 s29, s5
    s_mov_b32 s30, 0x500
    s_mov_b32 s31, 0x20000
    s_mov_b32 s56, s22
    s_mov_b32 s57, s23
    s_mov_b32 s58, 0x500
    s_mov_b32 s59, 0x20000
    s_mov_b32 s60, s20
    s_mov_b32 s61, s21
    s_mov_b32 s62, 0x21c000
    s_mov_b32 s63, 0x20000
    v_and_b32 v10, 1, v1
    v_lshlrev_b32 v10, 4, v10
    v_mov_b32 v11, 0xffff
    v_lshlrev_b32 v10, v10, v11
    v_bfe_u32 v11, v1, 1, 2
    v_cmp_eq_u32 vcc, 0, v11
    s_nop 1
    v_cndmask_b32 v6, 0, v10, vcc
    v_cmp_eq_u32 vcc, 1, v11
    s_nop 1
    v_cndmask_b32 v7, 0, v10, vcc
    v_cmp_eq_u32 vcc, 2, v11
    s_nop 1
    v_cndmask_b32 v8, 0, v10, vcc
    v_cmp_eq_u32 vcc, 3, v11
    s_nop 1
    v_cndmask_b32 v9, 0, v10, vcc
    s_branch L_sw3
L_w0:
    s_mov_b64 exec, -1
    v_lshlrev_b32 v10, 3, v1
    s_lshl_b32 s76, s67, 9
    s_add_u32 s76, s76, 65536
    s_lshl_b32 s77, s65, 12
    s_add_u32 s77, s77, 65536
    s_mov_b32 s86, 0
L_pc:
    s_add_u32 s86, s86, 1
    s_cmp_gt_u32 s86, 1048576
    s_cbranch_scc1 L_pcx
    ds_read_b32 v15, v14 offset:4356
    s_waitcnt lgkmcnt(0)
    v_readfirstlane_b32 s79, v15
    s_cmp_lt_u32 s79, 3
    s_cbranch_scc1 L_pc
L_pcx:
    ds_read_b64 v[208:209], v10 offset:0
    ds_read_b64 v[210:211], v10 offset:512
    ds_read_b64 v[212:213], v10 offset:1024
    ds_read_b64 v[214:215], v10 offset:1536
    s_add_u32 s52, s55, 1
    s_and_b32 s53, s52, 0xff
    s_and_b32 s54, s52, 15
    v_mov_b32 v13, s54
    s_waitcnt lgkmcnt(0)
    v_add_f32 v208, v208, v210
    v_add_f32 v212, v212, v214
    v_add_f32 v208, v208, v212
    v_add_f32 v209, v209, v211
    v_add_f32 v213, v213, v215
    v_add_f32 v209, v209, v213
    v_and_or_b32 v208, v208, -16, v13
    v_and_or_b32 v209, v209, -16, v13
    s_add_u32 s78, s76, 131072
    s_add_u32 s79, s77, 131072
    buffer_store_dwordx2 v[208:209], v10, s[48:51], s78 offen
    buffer_store_dwordx2 v[208:209], v10, s[48:51], s76 offen sc1
    buffer_load_dwordx4 v[48:51], v3, s[32:35], s70 offen offset:0 nt
    buffer_load_dwordx4 v[52:55], v3, s[32:35], s70 offen offset:1024 nt
    buffer_load_dwordx4 v[56:59], v3, s[32:35], s70 offen offset:2048 nt
    buffer_load_dwordx4 v[60:63], v3, s[32:35], s70 offen offset:3072 nt
    buffer_load_dwordx4 v[64:67], v3, s[32:35], s71 offen offset:0 nt
    buffer_load_dwordx4 v[68:71], v3, s[32:35], s71 offen offset:1024 nt
    buffer_load_dwordx4 v[72:75], v3, s[32:35], s71 offen offset:2048 nt
    buffer_load_dwordx4 v[76:79], v3, s[32:35], s71 offen offset:3072 nt
    buffer_load_dwordx4 v[208:211], v2, s[48:51], s79 offen offset:0 sc1
    buffer_load_dwordx4 v[212:215], v2, s[48:51], s79 offen offset:1024 sc1
    buffer_load_dwordx4 v[216:219], v2, s[48:51], s79 offen offset:2048 sc1
    buffer_load_dwordx4 v[220:223], v2, s[48:51], s79 offen offset:3072 sc1
    buffer_load_dwordx4 v[80:83], v3, s[32:35], s72 offen offset:0 nt
    buffer_load_dwordx4 v[84:87], v3, s[32:35], s72 offen offset:1024 nt
    buffer_load_dwordx4 v[88:91], v3, s[32:35], s72 offen offset:2048 nt
    buffer_load_dwordx4 v[92:95], v3, s[32:35], s72 offen offset:3072 nt
    buffer_load_dwordx4 v[96:99], v3, s[32:35], s73 offen offset:0 nt
    buffer_load_dwordx4 v[100:103], v3, s[32:35], s73 offen offset:1024 nt
    buffer_load_dwordx4 v[104:107], v3, s[32:35], s73 offen offset:2048 nt
    buffer_load_dwordx4 v[108:111], v3, s[32:35], s73 offen offset:3072 nt
    buffer_load_dwordx4 v[224:227], v2, s[48:51], s79 offen offset:0 sc1
    buffer_load_dwordx4 v[228:231], v2, s[48:51], s79 offen offset:1024 sc1
    buffer_load_dwordx4 v[232:235], v2, s[48:51], s79 offen offset:2048 sc1
    buffer_load_dwordx4 v[236:239], v2, s[48:51], s79 offen offset:3072 sc1
    buffer_load_dwordx4 v[112:115], v47, s[36:39], s70 offen offset:0 nt
    buffer_load_dwordx4 v[116:119], v47, s[36:39], s70 offen offset:1024 nt
    buffer_load_dwordx4 v[120:123], v47, s[36:39], s70 offen offset:2048 nt
    buffer_load_dwordx4 v[124:127], v47, s[36:39], s70 offen offset:3072 nt
    buffer_load_dwordx4 v[128:131], v47, s[36:39], s71 offen offset:0 nt
    buffer_load_dwordx4 v[132:135], v47, s[36:39], s71 offen offset:1024 nt
    buffer_load_dwordx4 v[136:139], v47, s[36:39], s71 offen offset:2048 nt
    buffer_load_dwordx4 v[140:143], v47, s[36:39], s71 offen offset:3072 nt
    buffer_load_dwordx4 v[240:243], v2, s[48:51], s79 offen offset:0 sc1
    buffer_load_dwordx4 v[244:247], v2, s[48:51], s79 offen offset:1024 sc1
    buffer_load_dwordx4 v[248:251], v2, s[48:51], s79 offen offset:2048 sc1
    buffer_load_dwordx4 v[252:255], v2, s[48:51], s79 offen offset:3072 sc1
    buffer_load_dwordx4 v[144:147], v47, s[36:39], s72 offen offset:0 nt
    buffer_load_dwordx4 v[148:151], v47, s[36:39], s72 offen offset:1024 nt
    buffer_load_dwordx4 v[152:155], v47, s[36:39], s72 offen offset:2048 nt
    buffer_load_dwordx4 v[156:159], v47, s[36:39], s72 offen offset:3072 nt
    buffer_load_dwordx4 v[160:163], v47, s[36:39], s73 offen offset:0 nt
    buffer_load_dwordx4 v[164:167], v47, s[36:39], s73 offen offset:1024 nt
    buffer_load_dwordx4 v[168:171], v47, s[36:39], s73 offen offset:2048 nt
    buffer_load_dwordx4 v[172:175], v47, s[36:39], s73 offen offset:3072 nt
    v_and_b32 v10, 31, v1
    v_lshlrev_b32 v10, 3, v10
    s_mov_b32 s86, 0
    s_waitcnt vmcnt(32)
    v_xor_b32 v208, s54, v208
    v_xor_b32 v209, s54, v209
    v_xor_b32 v210, s54, v210
    v_xor_b32 v211, s54, v211
    v_xor_b32 v212, s54, v212
    v_xor_b32 v213, s54, v213
    v_xor_b32 v214, s54, v214
    v_xor_b32 v215, s54, v215
    v_xor_b32 v216, s54, v216
    v_xor_b32 v217, s54, v217
    v_xor_b32 v218, s54, v218
    v_xor_b32 v219, s54, v219
    v_xor_b32 v220, s54, v220
    v_xor_b32 v221, s54, v221
    v_xor_b32 v222, s54, v222
    v_xor_b32 v223, s54, v223
    v_or3_b32 v13, v208, v209, v210
    v_or3_b32 v13, v13, v211, v212
    v_or3_b32 v13, v13, v213, v214
    v_or3_b32 v13, v13, v215, v216
    v_or3_b32 v13, v13, v217, v218
    v_or3_b32 v13, v13, v219, v220
    v_or3_b32 v13, v13, v221, v222
    v_or_b32 v13, v13, v223
    v_and_b32 v13, 0xf, v13
    v_cmp_ne_u32 vcc, 0, v13
    s_cmp_lg_u64 vcc, 0
    s_cbranch_scc0 L_pgx
    s_waitcnt vmcnt(20)
    v_pk_mov_b32 v[208:209], v[224:225], v[224:225] op_sel:[0,1]
    v_pk_mov_b32 v[210:211], v[226:227], v[226:227] op_sel:[0,1]
    v_pk_mov_b32 v[212:213], v[228:229], v[228:229] op_sel:[0,1]
    v_pk_mov_b32 v[214:215], v[230:231], v[230:231] op_sel:[0,1]
    v_pk_mov_b32 v[216:217], v[232:233], v[232:233] op_sel:[0,1]
    v_pk_mov_b32 v[218:219], v[234:235], v[234:235] op_sel:[0,1]
    v_pk_mov_b32 v[220:221], v[236:237], v[236:237] op_sel:[0,1]
    v_pk_mov_b32 v[222:223], v[238:239], v[238:239] op_sel:[0,1]
    v_xor_b32 v208, s54, v208
    v_xor_b32 v209, s54, v209
    v_xor_b32 v210, s54, v210
    v_xor_b32 v211, s54, v211
    v_xor_b32 v212, s54, v212
    v_xor_b32 v213, s54, v213
    v_xor_b32 v214, s54, v214
    v_xor_b32 v215, s54, v215
    v_xor_b32 v216, s54, v216
    v_xor_b32 v217, s54, v217
    v_xor_b32 v218, s54, v218
    v_xor_b32 v219, s54, v219
    v_xor_b32 v220, s54, v220
    v_xor_b32 v221, s54, v221
    v_xor_b32 v222, s54, v222
    v_xor_b32 v223, s54, v223
    v_or3_b32 v13, v208, v209, v210
    v_or3_b32 v13, v13, v211, v212
    v_or3_b32 v13, v13, v213, v214
    v_or3_b32 v13, v13, v215, v216
    v_or3_b32 v13, v13, v217, v218
    v_or3_b32 v13, v13, v219, v220
    v_or3_b32 v13, v13, v221, v222
    v_or_b32 v13, v13, v223
    v_and_b32 v13, 0xf, v13
    v_cmp_ne_u32 vcc, 0, v13
    s_cmp_lg_u64 vcc, 0
    s_cbranch_scc0 L_pgx
    s_waitcnt vmcnt(8)
    v_pk_mov_b32 v[208:209], v[240:241], v[240:241] op_sel:[0,1]
    v_pk_mov_b32 v[210:211], v[242:243], v[242:243] op_sel:[0,1]
    v_pk_mov_b32 v[212:213], v[244:245], v[244:245] op_sel:[0,1]
    v_pk_mov_b32 v[214:215], v[246:247], v[246:247] op_sel:[0,1]
    v_pk_mov_b32 v[216:217], v[248:249], v[248:249] op_sel:[0,1]
    v_pk_mov_b32 v[218:219], v[250:251], v[250:251] op_sel:[0,1]
    v_pk_mov_b32 v[220:221], v[252:253], v[252:253] op_sel:[0,1]
    v_pk_mov_b32 v[222:223], v[254:255], v[254:255] op_sel:[0,1]
L_pg:
    v_xor_b32 v208, s54, v208
    v_xor_b32 v209, s54, v209
    v_xor_b32 v210, s54, v210
    v_xor_b32 v211, s54, v211
    v_xor_b32 v212, s54, v212
    v_xor_b32 v213, s54, v213
    v_xor_b32 v214, s54, v214
    v_xor_b32 v215, s54, v215
    v_xor_b32 v216, s54, v216
    v_xor_b32 v217, s54, v217
    v_xor_b32 v218, s54, v218
    v_xor_b32 v219, s54, v219
    v_xor_b32 v220, s54, v220
    v_xor_b32 v221, s54, v221
    v_xor_b32 v222, s54, v222
    v_xor_b32 v223, s54, v223
    v_or3_b32 v13, v208, v209, v210
    v_or3_b32 v13, v13, v211, v212
    v_or3_b32 v13, v13, v213, v214
    v_or3_b32 v13, v13, v215, v216
    v_or3_b32 v13, v13, v217, v218
    v_or3_b32 v13, v13, v219, v220
    v_or3_b32 v13, v13, v221, v222
    v_or_b32 v13, v13, v223
    v_and_b32 v13, 0xf, v13
    v_cmp_ne_u32 vcc, 0, v13
    s_cmp_lg_u64 vcc, 0
    s_cbranch_scc0 L_pgx
    s_add_u32 s86, s86, 1
    s_cmp_gt_u32 s86, 65536
    s_cbranch_scc1 L_pgx
    buffer_load_dwordx4 v[208:211], v2, s[48:51], s77 offen offset:0 sc1
    buffer_load_dwordx4 v[212:215], v2, s[48:51], s77 offen offset:1024 sc1
    buffer_load_dwordx4 v[216:219], v2, s[48:51], s77 offen offset:2048 sc1
    buffer_load_dwordx4 v[220:223], v2, s[48:51], s77 offen offset:3072 sc1
    s_waitcnt vmcnt(0)
    s_branch L_pg
L_pgx:
    v_add_f32 v208, v208, v212
    v_add_f32 v216, v216, v220
    v_add_f32 v208, v208, v216
    v_add_f32 v209, v209, v213
    v_add_f32 v217, v217, v221
    v_add_f32 v209, v209, v217
    v_add_f32 v210, v210, v214
    v_add_f32 v218, v218, v222
    v_add_f32 v210, v210, v218
    v_add_f32 v211, v211, v215
    v_add_f32 v219, v219, v223
    v_add_f32 v211, v211, v219
    v_mov_b32 v212, v208
    v_mov_b32 v213, v209
    v_mov_b32 v214, v210
    v_mov_b32 v215, v211
    v_permlane32_swap_b32 v208, v212
    v_permlane32_swap_b32 v209, v213
    v_permlane32_swap_b32 v210, v214
    v_permlane32_swap_b32 v211, v215
    v_add_f32 v208, v208, v212
    v_add_f32 v209, v209, v213
    v_add_f32 v210, v210, v214
    v_add_f32 v211, v211, v215
    v_cvt_pk_bf16_f32 v208, v208, v209
    v_cvt_pk_bf16_f32 v209, v210, v211
    v_mov_b32 v13, 1
    ds_write_b64 v10, v[208:209] offset:4096
    ds_write_b32 v14, v13 offset:4352
    s_branch L_merge
L_w0c:
    s_setprio 2
    buffer_load_dwordx4 v[48:51], v3, s[32:35], s70 offen offset:0 nt
    buffer_load_dwordx4 v[52:55], v3, s[32:35], s70 offen offset:1024 nt
    buffer_load_dwordx4 v[56:59], v3, s[32:35], s70 offen offset:2048 nt
    buffer_load_dwordx4 v[60:63], v3, s[32:35], s70 offen offset:3072 nt
    buffer_load_dwordx4 v[64:67], v3, s[32:35], s71 offen offset:0 nt
    buffer_load_dwordx4 v[68:71], v3, s[32:35], s71 offen offset:1024 nt
L_sw3:
    buffer_load_dwordx4 v[72:75], v3, s[32:35], s71 offen offset:2048 nt
    buffer_load_dwordx4 v[76:79], v3, s[32:35], s71 offen offset:3072 nt
    buffer_load_dwordx4 v[80:83], v3, s[32:35], s72 offen offset:0 nt
    buffer_load_dwordx4 v[84:87], v3, s[32:35], s72 offen offset:1024 nt
    buffer_load_dwordx4 v[88:91], v3, s[32:35], s72 offen offset:2048 nt
    buffer_load_dwordx4 v[92:95], v3, s[32:35], s72 offen offset:3072 nt
    buffer_load_dwordx4 v[96:99], v3, s[32:35], s73 offen offset:0 nt
    buffer_load_dwordx4 v[100:103], v3, s[32:35], s73 offen offset:1024 nt
    buffer_load_dwordx4 v[104:107], v3, s[32:35], s73 offen offset:2048 nt
    buffer_load_dwordx4 v[108:111], v3, s[32:35], s73 offen offset:3072 nt
    buffer_load_dwordx4 v[112:115], v47, s[36:39], s70 offen offset:0 nt
    s_setprio 1
    buffer_load_dwordx4 v[116:119], v47, s[36:39], s70 offen offset:1024 nt
    buffer_load_dwordx4 v[120:123], v47, s[36:39], s70 offen offset:2048 nt
    buffer_load_dwordx4 v[124:127], v47, s[36:39], s70 offen offset:3072 nt
    buffer_load_dwordx4 v[128:131], v47, s[36:39], s71 offen offset:0 nt
    buffer_load_dwordx4 v[132:135], v47, s[36:39], s71 offen offset:1024 nt
    buffer_load_dwordx4 v[136:139], v47, s[36:39], s71 offen offset:2048 nt
    buffer_load_dwordx4 v[140:143], v47, s[36:39], s71 offen offset:3072 nt
    buffer_load_dwordx4 v[144:147], v47, s[36:39], s72 offen offset:0 nt
    buffer_load_dwordx4 v[148:151], v47, s[36:39], s72 offen offset:1024 nt
    buffer_load_dwordx4 v[152:155], v47, s[36:39], s72 offen offset:2048 nt
    buffer_load_dwordx4 v[156:159], v47, s[36:39], s72 offen offset:3072 nt
    buffer_load_dwordx4 v[160:163], v47, s[36:39], s73 offen offset:0 nt
    buffer_load_dwordx4 v[164:167], v47, s[36:39], s73 offen offset:1024 nt
    buffer_load_dwordx4 v[168:171], v47, s[36:39], s73 offen offset:2048 nt
    buffer_load_dwordx4 v[172:175], v47, s[36:39], s73 offen offset:3072 nt
L_merge:
    s_branch L_pad
    .p2align 12
L_pad:
    v_lshrrev_b32 v10, 4, v1
    v_lshlrev_b32 v11, 4, v10
    v_mov_b32 v14, 0
    s_mov_b32 s86, 0
L_qf:
    s_add_u32 s86, s86, 1
    s_cmp_gt_u32 s86, 1048576
    s_cbranch_scc1 L_qfx
    ds_read_b32 v15, v14 offset:4352
    s_waitcnt lgkmcnt(0)
    v_readfirstlane_b32 s76, v15
    s_cmp_eq_u32 s76, 0
    s_cbranch_scc1 L_qf
L_qfx:
    s_add_u32 s52, s55, 1
    s_and_b32 s53, s52, 0xff
    s_and_b32 s54, s52, 15
    v_bfe_u32 v12, v1, 2, 2
    v_lshl_add_u32 v12, v12, 6, v11
    ds_read_b128 v[32:35], v12 offset:4096
    s_mov_b32 vcc_lo, 0x11111111
    s_mov_b32 vcc_hi, 0x11111111
    s_waitcnt lgkmcnt(0)
    v_cndmask_b32 v16, 0, v32, vcc
    v_cndmask_b32 v17, 0, v33, vcc
    v_cndmask_b32 v18, 0, v34, vcc
    v_cndmask_b32 v19, 0, v35, vcc
    s_lshl_b64 vcc, vcc, 1
    v_cndmask_b32 v20, 0, v32, vcc
    v_cndmask_b32 v21, 0, v33, vcc
    v_cndmask_b32 v22, 0, v34, vcc
    v_cndmask_b32 v23, 0, v35, vcc
    s_lshl_b64 vcc, vcc, 1
    v_cndmask_b32 v24, 0, v32, vcc
    v_cndmask_b32 v25, 0, v33, vcc
    v_cndmask_b32 v26, 0, v34, vcc
    v_cndmask_b32 v27, 0, v35, vcc
    s_lshl_b64 vcc, vcc, 1
    v_cndmask_b32 v28, 0, v32, vcc
    v_cndmask_b32 v29, 0, v33, vcc
    v_cndmask_b32 v30, 0, v34, vcc
    v_cndmask_b32 v31, 0, v35, vcc
    s_waitcnt vmcnt(31)
    v_mfma_f32_16x16x32_bf16 v[32:35], v[48:51], v[16:19], 0
    s_waitcnt vmcnt(30)
    v_mfma_f32_16x16x32_bf16 v[32:35], v[52:55], v[20:23], v[32:35]
    s_waitcnt vmcnt(29)
    v_mfma_f32_16x16x32_bf16 v[32:35], v[56:59], v[24:27], v[32:35]
    s_waitcnt vmcnt(28)
    v_mfma_f32_16x16x32_bf16 v[32:35], v[60:63], v[28:31], v[32:35]
    s_waitcnt vmcnt(27)
    v_mfma_f32_16x16x32_bf16 v[36:39], v[64:67], v[16:19], 0
    s_waitcnt vmcnt(26)
    v_mfma_f32_16x16x32_bf16 v[36:39], v[68:71], v[20:23], v[36:39]
    s_waitcnt vmcnt(25)
    v_mfma_f32_16x16x32_bf16 v[36:39], v[72:75], v[24:27], v[36:39]
    s_waitcnt vmcnt(24)
    v_mfma_f32_16x16x32_bf16 v[36:39], v[76:79], v[28:31], v[36:39]
    s_waitcnt vmcnt(23)
    v_mfma_f32_16x16x32_bf16 v[40:43], v[80:83], v[16:19], 0
    s_waitcnt vmcnt(22)
    v_mfma_f32_16x16x32_bf16 v[40:43], v[84:87], v[20:23], v[40:43]
    s_waitcnt vmcnt(21)
    v_mfma_f32_16x16x32_bf16 v[40:43], v[88:91], v[24:27], v[40:43]
    s_waitcnt vmcnt(20)
    v_mfma_f32_16x16x32_bf16 v[40:43], v[92:95], v[28:31], v[40:43]
    s_waitcnt vmcnt(19)
    v_mfma_f32_16x16x32_bf16 v[48:51], v[96:99], v[16:19], 0
    s_waitcnt vmcnt(18)
    v_mfma_f32_16x16x32_bf16 v[48:51], v[100:103], v[20:23], v[48:51]
    s_waitcnt vmcnt(17)
    v_mfma_f32_16x16x32_bf16 v[48:51], v[104:107], v[24:27], v[48:51]
    s_waitcnt vmcnt(16)
    v_mfma_f32_16x16x32_bf16 v[48:51], v[108:111], v[28:31], v[48:51]
    v_mov_b32_dpp v32, v32 row_ror:8 row_mask:0xc bank_mask:0xf
    v_mov_b32_dpp v33, v33 row_ror:8 row_mask:0xc bank_mask:0xf
    v_mov_b32_dpp v34, v34 row_ror:8 row_mask:0xc bank_mask:0xf
    v_mov_b32_dpp v35, v35 row_ror:8 row_mask:0xc bank_mask:0xf
    v_mov_b32_dpp v36, v36 row_ror:8 row_mask:0xc bank_mask:0xf
    v_mov_b32_dpp v37, v37 row_ror:8 row_mask:0xc bank_mask:0xf
    v_mov_b32_dpp v38, v38 row_ror:8 row_mask:0xc bank_mask:0xf
    v_mov_b32_dpp v39, v39 row_ror:8 row_mask:0xc bank_mask:0xf
    v_mov_b32_dpp v40, v40 row_ror:8 row_mask:0xc bank_mask:0xf
    v_mov_b32_dpp v41, v41 row_ror:8 row_mask:0xc bank_mask:0xf
    v_mov_b32_dpp v42, v42 row_ror:8 row_mask:0xc bank_mask:0xf
    v_mov_b32_dpp v43, v43 row_ror:8 row_mask:0xc bank_mask:0xf
    v_mov_b32_dpp v48, v48 row_ror:8 row_mask:0xc bank_mask:0xf
    v_mov_b32_dpp v49, v49 row_ror:8 row_mask:0xc bank_mask:0xf
    v_mov_b32_dpp v50, v50 row_ror:8 row_mask:0xc bank_mask:0xf
    v_mov_b32_dpp v51, v51 row_ror:8 row_mask:0xc bank_mask:0xf
    v_permlane32_swap_b32 v32, v33
    v_permlane32_swap_b32 v34, v35
    v_permlane32_swap_b32 v36, v37
    v_permlane32_swap_b32 v38, v39
    v_permlane32_swap_b32 v40, v41
    v_permlane32_swap_b32 v42, v43
    v_permlane32_swap_b32 v48, v49
    v_permlane32_swap_b32 v50, v51
    v_add_f32 v32, v32, v33
    v_add_f32 v34, v34, v35
    v_add_f32 v36, v36, v37
    v_add_f32 v38, v38, v39
    v_add_f32 v40, v40, v41
    v_add_f32 v42, v42, v43
    v_add_f32 v48, v48, v49
    v_add_f32 v50, v50, v51
    v_mov_b32_dpp v32, v32 row_ror:12 row_mask:0xa bank_mask:0xf
    v_mov_b32_dpp v34, v34 row_ror:12 row_mask:0xa bank_mask:0xf
    v_mov_b32_dpp v36, v36 row_ror:12 row_mask:0xa bank_mask:0xf
    v_mov_b32_dpp v38, v38 row_ror:12 row_mask:0xa bank_mask:0xf
    v_mov_b32_dpp v40, v40 row_ror:12 row_mask:0xa bank_mask:0xf
    v_mov_b32_dpp v42, v42 row_ror:12 row_mask:0xa bank_mask:0xf
    v_mov_b32_dpp v48, v48 row_ror:12 row_mask:0xa bank_mask:0xf
    v_mov_b32_dpp v50, v50 row_ror:12 row_mask:0xa bank_mask:0xf
    v_permlane16_swap_b32 v32, v34
    v_permlane16_swap_b32 v36, v38
    v_permlane16_swap_b32 v40, v42
    v_permlane16_swap_b32 v48, v50
    v_add_f32 v32, v32, v34
    v_add_f32 v36, v36, v38
    v_add_f32 v40, v40, v42
    v_add_f32 v48, v48, v50
    s_nop 0
    v_mov_b32_dpp v32, v40 row_ror:4 row_mask:0xf bank_mask:0x2
    s_nop 1
    v_mov_b32_dpp v32, v36 row_ror:8 row_mask:0xf bank_mask:0x4
    s_nop 1
    v_mov_b32_dpp v32, v48 row_ror:12 row_mask:0xf bank_mask:0x8
    v_cvt_pk_bf16_f32 v32, 0, v32
    v_mul_f32 v32, s88, v32
    v_cvt_pk_bf16_f32 v32, 0, v32
    s_nop 1
    v_max_f32_dpp v40, v32, v32 row_ror:8 row_mask:0xf bank_mask:0xf
    s_nop 1
    v_max_f32_dpp v40, v40, v40 row_ror:4 row_mask:0xf bank_mask:0xf
    s_nop 1
    v_max_f32_dpp v40, v40, v40 row_ror:2 row_mask:0xf bank_mask:0xf
    s_nop 1
    v_max_f32_dpp v40, v40, v40 row_ror:1 row_mask:0xf bank_mask:0xf
    v_mov_b32 v42, v40
    s_nop 1
    v_permlane16_swap_b32 v40, v42
    v_max_f32 v40, v40, v42
    v_mov_b32 v42, v40
    s_nop 1
    v_permlane32_swap_b32 v40, v42
    v_max_f32 v40, v40, v42
    v_mul_f32 v40, s87, v40
    v_fma_f32 v32, v32, s87, -v40
    v_exp_f32 v41, v32
    s_nop 0
    v_cvt_pk_bf16_f32 v33, v41, v41
    v_mov_b32 v32, v33
    s_nop 1
    v_mov_b32_dpp v32, v33 row_ror:4 row_mask:0xf bank_mask:0xa
    v_mov_b32_dpp v33, v33 row_ror:12 row_mask:0xf bank_mask:0x5
    s_nop 0
    v_and_b32_dpp v48, v32, v6 quad_perm:[0,0,0,0] row_mask:0xf bank_mask:0xf
    v_and_b32_dpp v49, v32, v7 quad_perm:[0,0,0,0] row_mask:0xf bank_mask:0xf
    v_and_b32_dpp v50, v32, v8 quad_perm:[0,0,0,0] row_mask:0xf bank_mask:0xf
    v_and_b32_dpp v51, v32, v9 quad_perm:[0,0,0,0] row_mask:0xf bank_mask:0xf
    v_and_b32_dpp v52, v32, v6 quad_perm:[1,1,1,1] row_mask:0xf bank_mask:0xf
    v_and_b32_dpp v53, v32, v7 quad_perm:[1,1,1,1] row_mask:0xf bank_mask:0xf
    v_and_b32_dpp v54, v32, v8 quad_perm:[1,1,1,1] row_mask:0xf bank_mask:0xf
    v_and_b32_dpp v55, v32, v9 quad_perm:[1,1,1,1] row_mask:0xf bank_mask:0xf
    v_and_b32_dpp v56, v32, v6 quad_perm:[2,2,2,2] row_mask:0xf bank_mask:0xf
    v_and_b32_dpp v57, v32, v7 quad_perm:[2,2,2,2] row_mask:0xf bank_mask:0xf
    v_and_b32_dpp v58, v32, v8 quad_perm:[2,2,2,2] row_mask:0xf bank_mask:0xf
    v_and_b32_dpp v59, v32, v9 quad_perm:[2,2,2,2] row_mask:0xf bank_mask:0xf
    v_and_b32_dpp v60, v32, v6 quad_perm:[3,3,3,3] row_mask:0xf bank_mask:0xf
    v_and_b32_dpp v61, v32, v7 quad_perm:[3,3,3,3] row_mask:0xf bank_mask:0xf
    v_and_b32_dpp v62, v32, v8 quad_perm:[3,3,3,3] row_mask:0xf bank_mask:0xf
    v_and_b32_dpp v63, v32, v9 quad_perm:[3,3,3,3] row_mask:0xf bank_mask:0xf
    v_and_b32_dpp v64, v33, v6 quad_perm:[0,0,0,0] row_mask:0xf bank_mask:0xf
    v_and_b32_dpp v65, v33, v7 quad_perm:[0,0,0,0] row_mask:0xf bank_mask:0xf
    v_and_b32_dpp v66, v33, v8 quad_perm:[0,0,0,0] row_mask:0xf bank_mask:0xf
    v_and_b32_dpp v67, v33, v9 quad_perm:[0,0,0,0] row_mask:0xf bank_mask:0xf
    v_and_b32_dpp v68, v33, v6 quad_perm:[1,1,1,1] row_mask:0xf bank_mask:0xf
    v_and_b32_dpp v69, v33, v7 quad_perm:[1,1,1,1] row_mask:0xf bank_mask:0xf
    v_and_b32_dpp v70, v33, v8 quad_perm:[1,1,1,1] row_mask:0xf bank_mask:0xf
    v_and_b32_dpp v71, v33, v9 quad_perm:[1,1,1,1] row_mask:0xf bank_mask:0xf
    v_and_b32_dpp v72, v33, v6 quad_perm:[2,2,2,2] row_mask:0xf bank_mask:0xf
    v_and_b32_dpp v73, v33, v7 quad_perm:[2,2,2,2] row_mask:0xf bank_mask:0xf
    v_and_b32_dpp v74, v33, v8 quad_perm:[2,2,2,2] row_mask:0xf bank_mask:0xf
    v_and_b32_dpp v75, v33, v9 quad_perm:[2,2,2,2] row_mask:0xf bank_mask:0xf
    v_and_b32_dpp v76, v33, v6 quad_perm:[3,3,3,3] row_mask:0xf bank_mask:0xf
    v_and_b32_dpp v77, v33, v7 quad_perm:[3,3,3,3] row_mask:0xf bank_mask:0xf
    v_and_b32_dpp v78, v33, v8 quad_perm:[3,3,3,3] row_mask:0xf bank_mask:0xf
    v_and_b32_dpp v79, v33, v9 quad_perm:[3,3,3,3] row_mask:0xf bank_mask:0xf
    v_add_f32_dpp v41, v41, v41 row_ror:8 row_mask:0xf bank_mask:0xf
    s_nop 1
    v_add_f32_dpp v41, v41, v41 row_ror:4 row_mask:0xf bank_mask:0xf
    s_nop 1
    v_add_f32_dpp v41, v41, v41 row_ror:2 row_mask:0xf bank_mask:0xf
    s_nop 1
    v_add_f32_dpp v41, v41, v41 row_ror:1 row_mask:0xf bank_mask:0xf
    v_mov_b32 v42, v41
    s_nop 1
    v_permlane16_swap_b32 v41, v42
    v_add_f32 v41, v41, v42
    v_mov_b32 v42, v41
    s_nop 1
    v_permlane32_swap_b32 v41, v42
    v_add_f32 v41, v41, v42
    v_mul_f32 v41, 0.5, v41
    v_bfe_u32 v12, v1, 3, 1
    s_lshl_b32 s76, s64, 1
    v_add_u32 v12, s76, v12
    v_lshlrev_b32 v12, 3, v12
    s_mov_b64 exec, 0x101
    ds_write_b64 v12, v[40:41] offset:13056
    s_mov_b64 exec, -1
    v_lshrrev_b32 v12, 5, v1
    v_add_u32 v12, s76, v12
    v_mul_u32_u24 v12, 528, v12
    v_and_b32 v13, 15, v1
    v_lshl_add_u32 v12, v13, 5, v12
    v_bfe_u32 v14, v1, 4, 1
    v_lshl_add_u32 v12, v14, 4, v12
    v_mul_u32_u24 v15, 528, v13
    s_lshl_b32 s76, s64, 6
    v_add3_u32 v15, v15, v11, s76
    v_lshlrev_b32 v14, 3, v13
    s_lshr_b32 s76, s64, 2
    s_lshl_b32 s77, s65, 1
    s_add_u32 s76, s76, s77
    s_lshl_b32 s76, s76, 3
    s_add_u32 s76, s76, s66
    s_lshl_b32 s76, s76, 2
    s_and_b32 s77, s64, 3
    s_add_u32 s76, s76, s77
    s_lshl_b32 s76, s76, 6
    s_add_u32 s40, s76, 1048576
    s_lshl_b32 s76, s67, 6
    s_add_u32 s76, s76, 1179648
    s_cmp_eq_u32 s64, 7
    s_cselect_b32 s41, s76, 0x10000000
    v_mov_b32 v13, v11
    s_waitcnt vmcnt(15)
    v_mfma_f32_16x16x32_bf16 v[32:35], v[48:51], v[112:115], 0
    s_waitcnt vmcnt(14)
    v_mfma_f32_16x16x32_bf16 v[32:35], v[52:55], v[116:119], v[32:35]
    s_waitcnt vmcnt(13)
    v_mfma_f32_16x16x32_bf16 v[32:35], v[56:59], v[120:123], v[32:35]
    s_waitcnt vmcnt(12)
    v_mfma_f32_16x16x32_bf16 v[32:35], v[60:63], v[124:127], v[32:35]
    s_waitcnt vmcnt(11)
    v_mfma_f32_16x16x32_bf16 v[36:39], v[48:51], v[128:131], 0
    s_waitcnt vmcnt(10)
    v_mfma_f32_16x16x32_bf16 v[36:39], v[52:55], v[132:135], v[36:39]
    s_waitcnt vmcnt(9)
    v_mfma_f32_16x16x32_bf16 v[36:39], v[56:59], v[136:139], v[36:39]
    s_waitcnt vmcnt(8)
    v_mfma_f32_16x16x32_bf16 v[36:39], v[60:63], v[140:143], v[36:39]
    s_waitcnt vmcnt(7)
    v_mfma_f32_16x16x32_bf16 v[32:35], v[64:67], v[144:147], v[32:35]
    v_lshrrev_b32 v97, 4, v1
    v_bfe_u32 v98, v1, 4, 1
    v_and_b32 v100, 15, v1
    v_min_u32 v100, 9, v100
    v_mad_u32_u24 v100, v98, 10, v100
    v_lshrrev_b32 v101, 5, v1
    v_lshlrev_b32 v99, 3, v100
    v_lshl_add_u32 v99, v101, 2, v99
    v_mul_u32_u24 v102, 10240, v101
    v_lshl_add_u32 v102, v100, 4, v102
    v_mul_u32_u24 v98, 20, v98
    v_add_u32 v98, v98, v101
    v_bfe_u32 v100, v1, 3, 1
    v_lshl_add_u32 v98, v98, 1, v100
    v_mul_u32_u24 v100, 3456, v98
    v_and_b32 v101, 3, v1
    v_lshl_add_u32 v100, v101, 4, v100
    s_mul_i32 s76, s64, 276480
    s_lshl_b32 s77, s69, 6
    s_add_u32 s76, s76, s77
    v_add_u32 v100, s76, v100
    v_mov_b32 v101, 0
    v_mov_b32 v208, s16
    v_mov_b32 v209, s17
    v_mov_b32 v210, s18
    v_mov_b32 v211, s19
    s_mov_b32 vcc_lo, 0xf0f0f0f0
    s_mov_b32 vcc_hi, 0xf0f0f0f0
    v_cndmask_b32 v208, v208, v210, vcc
    v_cndmask_b32 v209, v209, v211, vcc
    s_mov_b32 s78, 13824
    s_mov_b32 s79, 0
    v_lshl_add_u64 v[208:209], v[100:101], 0, v[208:209]
    v_lshl_add_u64 v[210:211], v[208:209], 0, s[78:79]
    v_lshl_add_u64 v[212:213], v[210:211], 0, s[78:79]
    v_lshl_add_u64 v[214:215], v[212:213], 0, s[78:79]
    v_lshl_add_u64 v[216:217], v[214:215], 0, s[78:79]
    v_lshl_add_u64 v[218:219], v[216:217], 0, s[78:79]
    v_lshl_add_u64 v[220:221], v[218:219], 0, s[78:79]
    v_lshl_add_u64 v[222:223], v[220:221], 0, s[78:79]
    v_lshl_add_u64 v[224:225], v[222:223], 0, s[78:79]
    v_lshl_add_u64 v[226:227], v[224:225], 0, s[78:79]
    v_mul_u32_u24 v96, 10240, v97
    v_and_b32 v101, 15, v1
    v_lshl_add_u32 v96, v101, 4, v96
    s_mul_i32 s42, s69, 40960
    s_lshl_b32 s77, s64, 8
    s_add_u32 s42, s42, s77
    s_cmp_ge_u32 s64, 5
    s_cselect_b32 s42, 0x10000000, s42
    s_add_u32 s43, s42, 5120
    s_waitcnt vmcnt(6)
    v_mfma_f32_16x16x32_bf16 v[32:35], v[68:71], v[148:151], v[32:35]
    s_waitcnt vmcnt(5)
    v_mfma_f32_16x16x32_bf16 v[32:35], v[72:75], v[152:155], v[32:35]
    s_waitcnt vmcnt(4)
    v_mfma_f32_16x16x32_bf16 v[32:35], v[76:79], v[156:159], v[32:35]
    s_waitcnt vmcnt(3)
    v_mfma_f32_16x16x32_bf16 v[36:39], v[64:67], v[160:163], v[36:39]
    s_waitcnt vmcnt(2)
    v_mfma_f32_16x16x32_bf16 v[36:39], v[68:71], v[164:167], v[36:39]
    s_waitcnt vmcnt(1)
    v_mfma_f32_16x16x32_bf16 v[36:39], v[72:75], v[168:171], v[36:39]
    s_waitcnt vmcnt(0)
    v_mfma_f32_16x16x32_bf16 v[36:39], v[76:79], v[172:175], v[36:39]
    s_nop 7
    v_cndmask_b32 v32, v36, v32, s[82:83]
    v_cndmask_b32 v33, v37, v33, s[82:83]
    v_cndmask_b32 v34, v38, v34, s[82:83]
    v_cndmask_b32 v35, v39, v35, s[82:83]
    ds_write_b128 v12, v[32:35] offset:4608
    s_cmp_eq_u32 s68, -1
    s_cbranch_scc1 L_nwo
    s_setprio 0
    buffer_load_dwordx4 v[176:179], v4, s[44:47], s74 offen nt
    s_add_u32 s74, s74, 5120
    buffer_load_dwordx4 v[180:183], v4, s[44:47], s74 offen nt
    s_add_u32 s74, s74, 5120
    buffer_load_dwordx4 v[184:187], v4, s[44:47], s74 offen nt
    s_add_u32 s74, s74, 5120
    buffer_load_dwordx4 v[188:191], v4, s[44:47], s74 offen nt
    s_add_u32 s74, s74, 5120
    buffer_load_dwordx4 v[192:195], v4, s[44:47], s74 offen nt
    s_add_u32 s74, s74, 5120
    buffer_load_dwordx4 v[196:199], v4, s[44:47], s74 offen nt
    s_add_u32 s74, s74, 5120
    buffer_load_dwordx4 v[200:203], v4, s[44:47], s74 offen nt
    s_add_u32 s74, s74, 5120
    buffer_load_dwordx4 v[204:207], v4, s[44:47], s74 offen nt
    s_add_u32 s74, s74, 5120
    s_setprio 2
L_nwo:
    v_mov_b32 v44, s52
    v_mov_b32 v45, s52
    v_mov_b32 v11, s53
    s_add_u32 s76, s40, 262144
    s_add_u32 s77, s41, 262144
    s_waitcnt lgkmcnt(0)
    s_barrier
    ds_read_b64 v[40:41], v14 offset:13056
    ds_read_b128 v[32:35], v15 offset:4608
    s_waitcnt lgkmcnt(1)
    v_max_f32_dpp v42, v40, v40 row_ror:8 row_mask:0xf bank_mask:0xf
    s_nop 1
    v_max_f32_dpp v42, v42, v42 row_ror:4 row_mask:0xf bank_mask:0xf
    s_nop 1
    v_max_f32_dpp v42, v42, v42 row_ror:2 row_mask:0xf bank_mask:0xf
    v_sub_f32 v40, v40, v42
    v_exp_f32 v40, v40
    s_waitcnt lgkmcnt(0)
    v_mul_f32 v32, v32, v40
    v_mul_f32 v33, v33, v40
    v_mul_f32 v34, v34, v40
    v_mul_f32 v35, v35, v40
    v_mul_f32 v43, v41, v40
    v_add_f32_dpp v32, v32, v32 row_ror:8 row_mask:0xf bank_mask:0xf
    v_add_f32_dpp v33, v33, v33 row_ror:8 row_mask:0xf bank_mask:0xf
    v_add_f32_dpp v34, v34, v34 row_ror:8 row_mask:0xf bank_mask:0xf
    v_add_f32_dpp v35, v35, v35 row_ror:8 row_mask:0xf bank_mask:0xf
    v_add_f32_dpp v43, v43, v43 row_ror:8 row_mask:0xf bank_mask:0xf
    v_add_f32_dpp v32, v32, v32 row_ror:4 row_mask:0xf bank_mask:0xf
    v_add_f32_dpp v33, v33, v33 row_ror:4 row_mask:0xf bank_mask:0xf
    v_add_f32_dpp v34, v34, v34 row_ror:4 row_mask:0xf bank_mask:0xf
    v_add_f32_dpp v35, v35, v35 row_ror:4 row_mask:0xf bank_mask:0xf
    v_add_f32_dpp v43, v43, v43 row_ror:4 row_mask:0xf bank_mask:0xf
    v_add_f32_dpp v32, v32, v32 row_ror:2 row_mask:0xf bank_mask:0xf
    v_add_f32_dpp v33, v33, v33 row_ror:2 row_mask:0xf bank_mask:0xf
    v_add_f32_dpp v34, v34, v34 row_ror:2 row_mask:0xf bank_mask:0xf
    v_add_f32_dpp v35, v35, v35 row_ror:2 row_mask:0xf bank_mask:0xf
    v_add_f32_dpp v43, v43, v43 row_ror:2 row_mask:0xf bank_mask:0xf
    v_add_f32_dpp v32, v32, v32 row_ror:1 row_mask:0xf bank_mask:0xf
    v_add_f32_dpp v33, v33, v33 row_ror:1 row_mask:0xf bank_mask:0xf
    v_add_f32_dpp v34, v34, v34 row_ror:1 row_mask:0xf bank_mask:0xf
    v_add_f32_dpp v35, v35, v35 row_ror:1 row_mask:0xf bank_mask:0xf
    v_add_f32_dpp v43, v43, v43 row_ror:1 row_mask:0xf bank_mask:0xf
    v_and_or_b32 v32, v32, s3, v11
    v_and_or_b32 v33, v33, s3, v11
    v_and_or_b32 v34, v34, s3, v11
    v_and_or_b32 v35, v35, s3, v11
    s_mov_b32 exec_lo, 0x00010001
    s_mov_b32 exec_hi, 0x00010001
    buffer_store_dwordx4 v[32:35], v13, s[48:51], s40 offen
    buffer_store_dwordx4 v[42:45], v13, s[48:51], s41 offen
    buffer_store_dwordx4 v[32:35], v13, s[48:51], s76 offen sc1
    buffer_store_dwordx4 v[42:45], v13, s[48:51], s77 offen sc1
    s_mov_b64 exec, -1
    s_cmp_lg_u32 s69, -1
    s_cbranch_scc1 L_G
    s_cmp_eq_u32 s68, -1
    s_cbranch_scc1 L_P
    s_and_b32 s78, s2, 7
    s_lshl_b32 s76, s78, 3
    s_add_u32 s76, s76, s64
    s_lshl_b32 s40, s76, 11
    s_add_u32 s40, s40, 1048576
    s_lshr_b32 s76, s76, 1
    s_lshl_b32 s41, s76, 9
    s_add_u32 s41, s41, 1179648
    v_lshrrev_b32 v10, 4, v1
    v_add_u32 v12, v10, v1
    v_and_b32 v12, 7, v12
    v_lshlrev_b32 v12, 6, v12
    s_movk_i32 s79, 0xff
    buffer_load_dwordx4 v[112:115], v2, s[48:51], s40 offen offset:0 sc1
    buffer_load_dwordx4 v[116:119], v2, s[48:51], s40 offen offset:1024 sc1
    buffer_load_dwordx3 v[120:122], v12, s[48:51], s41 offen sc1
    v_mov_b32 v60, 0x01000100
    v_mov_b32 v61, 0x03020302
    v_cndmask_b32 v60, v61, v60, s[80:81]
    v_mov_b32 v61, 0x0c0c0c0c
    v_bfi_b32 v76, v6, v60, v61
    v_bfi_b32 v77, v7, v60, v61
    v_bfi_b32 v78, v8, v60, v61
    v_bfi_b32 v79, v9, v60, v61
    v_lshrrev_b32 v13, 5, v1
    s_lshl_b32 s76, s64, 1
    v_add_u32 v13, s76, v13
    v_lshlrev_b32 v13, 8, v13
    v_and_b32 v60, 7, v1
    v_lshl_add_u32 v13, v60, 5, v13
    v_bfe_u32 v60, v1, 4, 1
    v_lshl_add_u32 v13, v60, 4, v13
    v_and_b32 v60, 15, v1
    v_lshlrev_b32 v60, 4, v60
    v_lshl_add_u32 v14, v10, 10, v60
    v_mul_u32_u24 v74, 0x5000, v10
    v_add_u32 v74, v74, v60
    v_mov_b32 v60, 0x10000000
    v_cmp_gt_u32 vcc, 4, v10
    s_nop 1
    v_cndmask_b32 v74, v60, v74, vcc
    v_mov_b32 v75, s53
    s_waitcnt vmcnt(0)
    v_max_f32_dpp v60, v120, v120 row_half_mirror row_mask:0xf bank_mask:0xf
    v_xor_b32 v112, s53, v112
    v_xor_b32 v113, s53, v113
    v_xor_b32 v114, s53, v114
    v_max_f32_dpp v60, v60, v60 quad_perm:[2,3,0,1] row_mask:0xf bank_mask:0xf
    v_xor_b32 v115, s53, v115
    v_xor_b32 v116, s53, v116
    v_xor_b32 v117, s53, v117
    v_max_f32_dpp v60, v60, v60 quad_perm:[1,0,3,2] row_mask:0xf bank_mask:0xf
    v_xor_b32 v118, s53, v118
    v_xor_b32 v119, s53, v119
    v_sub_f32 v60, v120, v60
    v_xor_b32 v122, s52, v122
    v_exp_f32 v60, v60
    v_or3_b32 v62, v112, v113, v114
    v_mul_f32 v61, v60, v121
    v_or3_b32 v62, v62, v115, v116
    v_or3_b32 v62, v62, v117, v118
    v_add_f32_dpp v61, v61, v61 row_half_mirror row_mask:0xf bank_mask:0xf
    v_mul_f32_dpp v52, v60, v112 row_newbcast:0 row_mask:0xf bank_mask:0xf
    v_mul_f32_dpp v53, v60, v113 row_newbcast:0 row_mask:0xf bank_mask:0xf
    v_add_f32_dpp v61, v61, v61 quad_perm:[2,3,0,1] row_mask:0xf bank_mask:0xf
    v_mul_f32_dpp v54, v60, v114 row_newbcast:0 row_mask:0xf bank_mask:0xf
    v_mul_f32_dpp v55, v60, v115 row_newbcast:0 row_mask:0xf bank_mask:0xf
    v_add_f32_dpp v61, v61, v61 quad_perm:[1,0,3,2] row_mask:0xf bank_mask:0xf
    v_fmac_f32_dpp v52, v60, v116 row_newbcast:4 row_mask:0xf bank_mask:0xf
    v_fmac_f32_dpp v53, v60, v117 row_newbcast:4 row_mask:0xf bank_mask:0xf
    v_fmac_f32_dpp v54, v60, v118 row_newbcast:4 row_mask:0xf bank_mask:0xf
    v_fmac_f32_dpp v55, v60, v119 row_newbcast:4 row_mask:0xf bank_mask:0xf
    v_rcp_f32 v61, v61
    v_permlane32_swap_b32 v52, v53
    v_permlane32_swap_b32 v54, v55
    v_or_b32 v62, v62, v119
    v_add_f32 v52, v52, v53
    v_add_f32 v54, v54, v55
    v_and_or_b32 v62, v62, s79, v122
    s_nop 0
    v_permlane16_swap_b32 v52, v54
    v_cmp_ne_u32 vcc, 0, v62
    v_add_f32 v52, v52, v54
    v_mul_f32 v52, v52, v61
    s_nop 1
    v_mov_b32_dpp v53, v52 row_ror:8 row_mask:0xf bank_mask:0xf
    v_cvt_pk_bf16_f32 v94, v52, v53
    s_cmp_lg_u64 vcc, 0
    s_cbranch_scc1 L_o2e
L_o2x:
    v_mov_b32_dpp v92, v94 row_newbcast:0 row_mask:0xf bank_mask:0xf
    v_mov_b32_dpp v93, v94 row_newbcast:1 row_mask:0xf bank_mask:0xf
    v_perm_b32 v80, v92, v92, v76
    v_perm_b32 v81, v92, v92, v77
    v_perm_b32 v82, v92, v92, v78
    v_perm_b32 v83, v92, v92, v79
    v_perm_b32 v84, v93, v93, v76
    v_perm_b32 v85, v93, v93, v77
    v_perm_b32 v86, v93, v93, v78
    v_perm_b32 v87, v93, v93, v79
    v_mov_b32_dpp v92, v94 row_newbcast:2 row_mask:0xf bank_mask:0xf
    v_mfma_f32_16x16x32_bf16 v[96:99], v[80:83], v[176:179], 0
    v_perm_b32 v88, v92, v92, v76
    v_perm_b32 v89, v92, v92, v77
    v_perm_b32 v90, v92, v92, v78
    v_perm_b32 v91, v92, v92, v79
    v_mov_b32_dpp v93, v94 row_newbcast:3 row_mask:0xf bank_mask:0xf
    v_mfma_f32_16x16x32_bf16 v[96:99], v[84:87], v[180:183], v[96:99]
    v_perm_b32 v80, v93, v93, v76
    v_perm_b32 v81, v93, v93, v77
    v_perm_b32 v82, v93, v93, v78
    v_perm_b32 v83, v93, v93, v79
    v_mov_b32_dpp v92, v94 row_newbcast:4 row_mask:0xf bank_mask:0xf
    v_mfma_f32_16x16x32_bf16 v[96:99], v[88:91], v[184:187], v[96:99]
    v_perm_b32 v84, v92, v92, v76
    v_perm_b32 v85, v92, v92, v77
    v_perm_b32 v86, v92, v92, v78
    v_perm_b32 v87, v92, v92, v79
    v_mov_b32_dpp v93, v94 row_newbcast:5 row_mask:0xf bank_mask:0xf
    v_mfma_f32_16x16x32_bf16 v[96:99], v[80:83], v[188:191], v[96:99]
    v_perm_b32 v88, v93, v93, v76
    v_perm_b32 v89, v93, v93, v77
    v_perm_b32 v90, v93, v93, v78
    v_perm_b32 v91, v93, v93, v79
    v_mov_b32_dpp v92, v94 row_newbcast:6 row_mask:0xf bank_mask:0xf
    v_mfma_f32_16x16x32_bf16 v[96:99], v[84:87], v[192:195], v[96:99]
    v_perm_b32 v80, v92, v92, v76
    v_perm_b32 v81, v92, v92, v77
    v_perm_b32 v82, v92, v92, v78
    v_perm_b32 v83, v92, v92, v79
    v_mov_b32_dpp v93, v94 row_newbcast:7 row_mask:0xf bank_mask:0xf
    v_mfma_f32_16x16x32_bf16 v[96:99], v[88:91], v[196:199], v[96:99]
    v_perm_b32 v84, v93, v93, v76
    v_perm_b32 v85, v93, v93, v77
    v_perm_b32 v86, v93, v93, v78
    v_perm_b32 v87, v93, v93, v79
    v_mfma_f32_16x16x32_bf16 v[96:99], v[80:83], v[200:203], v[96:99]
    s_nop 0
    v_mfma_f32_16x16x32_bf16 v[96:99], v[84:87], v[204:207], v[96:99]
    s_mov_b32 exec_lo, 0x00ff00ff
    s_mov_b32 exec_hi, 0xff00ff00
    s_nop 5
    ds_write_b128 v13, v[96:99] offset:13312
    s_mov_b64 exec, -1
    s_and_b32 s78, s2, 7
    s_mul_i32 s76, s78, 2560
    s_lshl_b32 s77, s68, 8
    s_add_u32 s76, s76, s77
    s_add_u32 s76, s76, 1572864
    s_add_u32 s77, s76, 81920
    s_waitcnt lgkmcnt(0)
    s_barrier
    s_cmp_lg_u32 s64, 0
    s_cbranch_scc1 L_F
    ds_read_b128 v[16:19], v14 offset:13312
    ds_read_b128 v[20:23], v14 offset:13568
    ds_read_b128 v[24:27], v14 offset:13824
    ds_read_b128 v[28:31], v14 offset:14080
    s_waitcnt lgkmcnt(2)
    v_pk_add_f32 v[16:17], v[16:17], v[20:21]
    v_pk_add_f32 v[18:19], v[18:19], v[22:23]
    s_waitcnt lgkmcnt(0)
    v_pk_add_f32 v[24:25], v[24:25], v[28:29]
    v_pk_add_f32 v[26:27], v[26:27], v[30:31]
    v_pk_add_f32 v[16:17], v[16:17], v[24:25]
    v_pk_add_f32 v[18:19], v[18:19], v[26:27]
    s_nop 0
    v_permlane32_swap_b32 v16, v17
    v_permlane32_swap_b32 v18, v19
    v_add_f32 v16, v16, v17
    v_add_f32 v18, v18, v19
    s_nop 1
    v_permlane16_swap_b32 v16, v18
    v_add_f32 v16, v16, v18
    v_and_or_b32 v16, v16, s3, v75
    v_mov_b32 v18, v16
    s_nop 1
    v_permlane16_swap_b32 v16, v18
    v_mov_b32 v17, v16
    v_mov_b32 v19, v18
    s_nop 0
    v_permlane32_swap_b32 v16, v17
    v_permlane32_swap_b32 v18, v19
    buffer_store_dwordx4 v[16:19], v74, s[48:51], s76 offen sc1
    s_branch L_fin
L_o2e:
    s_mov_b32 s86, 0
L_o2:
    s_add_u32 s86, s86, 1
    s_cmp_gt_u32 s86, 65536
    s_cbranch_scc1 L_o2x
    s_cmp_eq_u32 s86, 24
    s_cselect_b32 s76, 262144, 0
    s_add_u32 s40, s40, s76
    s_add_u32 s41, s41, s76
    buffer_load_dwordx4 v[112:115], v2, s[48:51], s40 offen offset:0 sc1
    buffer_load_dwordx4 v[116:119], v2, s[48:51], s40 offen offset:1024 sc1
    buffer_load_dwordx3 v[120:122], v12, s[48:51], s41 offen sc1
    s_waitcnt vmcnt(0)
    v_max_f32_dpp v60, v120, v120 row_half_mirror row_mask:0xf bank_mask:0xf
    v_xor_b32 v112, s53, v112
    v_xor_b32 v113, s53, v113
    v_xor_b32 v114, s53, v114
    v_max_f32_dpp v60, v60, v60 quad_perm:[2,3,0,1] row_mask:0xf bank_mask:0xf
    v_xor_b32 v115, s53, v115
    v_xor_b32 v116, s53, v116
    v_xor_b32 v117, s53, v117
    v_max_f32_dpp v60, v60, v60 quad_perm:[1,0,3,2] row_mask:0xf bank_mask:0xf
    v_xor_b32 v118, s53, v118
    v_xor_b32 v119, s53, v119
    v_sub_f32 v60, v120, v60
    v_xor_b32 v122, s52, v122
    v_exp_f32 v60, v60
    v_or3_b32 v62, v112, v113, v114
    v_mul_f32 v61, v60, v121
    v_or3_b32 v62, v62, v115, v116
    v_or3_b32 v62, v62, v117, v118
    v_add_f32_dpp v61, v61, v61 row_half_mirror row_mask:0xf bank_mask:0xf
    v_mul_f32_dpp v52, v60, v112 row_newbcast:0 row_mask:0xf bank_mask:0xf
    v_mul_f32_dpp v53, v60, v113 row_newbcast:0 row_mask:0xf bank_mask:0xf
    v_add_f32_dpp v61, v61, v61 quad_perm:[2,3,0,1] row_mask:0xf bank_mask:0xf
    v_mul_f32_dpp v54, v60, v114 row_newbcast:0 row_mask:0xf bank_mask:0xf
    v_mul_f32_dpp v55, v60, v115 row_newbcast:0 row_mask:0xf bank_mask:0xf
    v_add_f32_dpp v61, v61, v61 quad_perm:[1,0,3,2] row_mask:0xf bank_mask:0xf
    v_fmac_f32_dpp v52, v60, v116 row_newbcast:4 row_mask:0xf bank_mask:0xf
    v_fmac_f32_dpp v53, v60, v117 row_newbcast:4 row_mask:0xf bank_mask:0xf
    v_fmac_f32_dpp v54, v60, v118 row_newbcast:4 row_mask:0xf bank_mask:0xf
    v_fmac_f32_dpp v55, v60, v119 row_newbcast:4 row_mask:0xf bank_mask:0xf
    v_rcp_f32 v61, v61
    v_permlane32_swap_b32 v52, v53
    v_permlane32_swap_b32 v54, v55
    v_or_b32 v62, v62, v119
    v_add_f32 v52, v52, v53
    v_add_f32 v54, v54, v55
    v_and_or_b32 v62, v62, s79, v122
    s_nop 0
    v_permlane16_swap_b32 v52, v54
    v_cmp_ne_u32 vcc, 0, v62
    v_add_f32 v52, v52, v54
    v_mul_f32 v52, v52, v61
    s_nop 1
    v_mov_b32_dpp v53, v52 row_ror:8 row_mask:0xf bank_mask:0xf
    v_cvt_pk_bf16_f32 v94, v52, v53
    s_cmp_lg_u64 vcc, 0
    s_cbranch_scc1 L_o2
    s_branch L_o2x
L_F:
    s_cmp_lg_u32 s64, 1
    s_cbranch_scc1 L_fin
    s_sub_u32 s68, s2, 40
    s_cbranch_scc1 L_fin
    v_bfe_u32 v73, v1, 5, 1
    v_bfe_u32 v64, v1, 4, 1
    v_lshl_add_u32 v73, v64, 1, v73
    v_and_b32 v64, 3, v1
    v_lshl_add_u32 v73, v64, 2, v73
    v_lshlrev_b32 v73, 1, v73
    s_lshl_b32 s78, s68, 5
    buffer_load_ushort v72, v73, s[28:31], s78 offen
    v_lshrrev_b32 v11, 2, v1
    v_mul_u32_u24 v11, 2560, v11
    v_lshl_add_u32 v11, v64, 4, v11
    v_mov_b32 v60, 0x10000000
    v_cndmask_b32 v11, v60, v11, s[82:83]
    v_cndmask_b32 v74, 0, v75, s[82:83]
    s_and_b32 s76, s2, 3
    s_mul_i32 s76, s76, 0x5000
    s_lshl_b32 s77, s68, 6
    s_add_u32 s76, s76, s77
    s_add_u32 s76, s76, 1572864
    v_cmp_gt_u32 vcc, 24, v1
    s_nop 1
    v_cndmask_b32 v10, v60, v2, vcc
    v_cndmask_b32 v75, 0, v75, vcc
    s_mov_b32 s86, 0
L_f0:
    s_add_u32 s86, s86, 1
    s_cmp_gt_u32 s86, 65536
    s_cbranch_scc1 L_f0x
    buffer_load_dwordx4 v[52:55], v11, s[48:51], s76 offen sc1
    s_waitcnt vmcnt(0)
    v_xor_b32 v52, v74, v52
    v_xor_b32 v53, v74, v53
    v_xor_b32 v54, v74, v54
    v_xor_b32 v55, v74, v55
    v_or3_b32 v60, v52, v53, v54
    v_or_b32 v60, v60, v55
    v_and_b32 v60, 0xff, v60
    v_cmp_ne_u32 vcc, 0, v60
    s_cmp_lg_u64 vcc, 0
    s_cbranch_scc1 L_f0
L_f0x:
    s_cmp_eq_u32 s68, 0
    s_cselect_b32 s76, 0, 0x10000000
    v_mov_b32 v60, s52
    v_mov_b32 v61, 0xf008
    s_mov_b64 exec, 1
    buffer_store_dword v60, v61, s[48:51], s76 offen sc1
    s_mov_b64 exec, -1
    s_mul_i32 s76, s68, 3456
    s_add_u32 s76, s76, 1769472
    v_lshlrev_b32 v72, 16, v72
    v_permlane32_swap_b32 v52, v53
    v_permlane32_swap_b32 v54, v55
    v_add_f32 v52, v52, v53
    v_add_f32 v54, v54, v55
    s_nop 1
    v_permlane16_swap_b32 v52, v54
    v_add_f32 v52, v52, v54
    s_nop 1
    v_add_f32_dpp v52, v52, v52 row_ror:4 row_mask:0xf bank_mask:0xf
    s_nop 1
    v_add_f32_dpp v52, v52, v52 row_ror:8 row_mask:0xf bank_mask:0xf
    v_cvt_pk_bf16_f32 v52, 0, v52
    v_add_f32 v72, v52, v72
    v_cvt_pk_bf16_f32 v72, 0, v72
    buffer_load_dwordx4 v[112:115], v2, s[48:51], s76 offen offset:0 sc1
    buffer_load_dwordx4 v[116:119], v2, s[48:51], s76 offen offset:1024 sc1
    buffer_load_dwordx4 v[120:123], v2, s[48:51], s76 offen offset:2048 sc1
    buffer_load_dwordx4 v[124:127], v10, s[48:51], s76 offen offset:3072 sc1
    buffer_load_dwordx4 v[128:131], v2, s[48:51], s76 offen offset:0 sc1
    buffer_load_dwordx4 v[132:135], v2, s[48:51], s76 offen offset:1024 sc1
    buffer_load_dwordx4 v[136:139], v2, s[48:51], s76 offen offset:2048 sc1
    buffer_load_dwordx4 v[140:143], v10, s[48:51], s76 offen offset:3072 sc1
    s_mov_b32 s86, 0
L_f1:
    s_add_u32 s86, s86, 1
    s_cmp_gt_u32 s86, 65536
    s_cbranch_scc1 L_f1x
    s_waitcnt vmcnt(4)
    v_xor_b32 v112, s53, v112
    v_xor_b32 v113, s53, v113
    v_xor_b32 v114, s53, v114
    v_xor_b32 v115, s53, v115
    v_xor_b32 v116, s53, v116
    v_xor_b32 v117, s53, v117
    v_xor_b32 v118, s53, v118
    v_xor_b32 v119, s53, v119
    v_xor_b32 v120, s53, v120
    v_xor_b32 v121, s53, v121
    v_xor_b32 v122, s53, v122
    v_xor_b32 v123, s53, v123
    v_xor_b32 v124, v75, v124
    v_xor_b32 v125, v75, v125
    v_xor_b32 v126, v75, v126
    v_xor_b32 v127, v75, v127
    v_or3_b32 v60, v112, v113, v114
    v_or3_b32 v60, v60, v115, v116
    v_or3_b32 v60, v60, v117, v118
    v_or3_b32 v60, v60, v119, v120
    v_or3_b32 v60, v60, v121, v122
    v_or3_b32 v60, v60, v123, v124
    v_or3_b32 v60, v60, v125, v126
    v_or_b32 v60, v60, v127
    v_and_b32 v60, 0xff, v60
    v_cmp_ne_u32 vcc, 0, v60
    v_pk_add_f32 v[112:113], v[112:113], v[116:117]
    v_pk_add_f32 v[114:115], v[114:115], v[118:119]
    v_pk_add_f32 v[120:121], v[120:121], v[124:125]
    v_pk_add_f32 v[122:123], v[122:123], v[126:127]
    v_pk_add_f32 v[88:89], v[112:113], v[120:121]
    v_pk_add_f32 v[90:91], v[114:115], v[122:123]
    s_nop 0
    v_permlane32_swap_b32 v88, v89
    v_permlane32_swap_b32 v90, v91
    v_add_f32 v88, v88, v89
    v_add_f32 v90, v90, v91
    s_nop 1
    v_permlane16_swap_b32 v88, v90
    v_add_f32 v88, v88, v90
    s_nop 1
    v_add_f32_dpp v88, v88, v88 row_ror:4 row_mask:0xf bank_mask:0xf
    s_nop 1
    v_add_f32_dpp v88, v88, v88 row_ror:8 row_mask:0xf bank_mask:0xf
    v_cvt_pk_bf16_f32 v88, 0, v88
    v_add_f32 v88, v88, v72
    v_cvt_pk_bf16_f32 v88, v88, v88
    s_cmp_lg_u64 vcc, 0
    s_cbranch_scc0 L_f1x
    buffer_load_dwordx4 v[112:115], v2, s[48:51], s76 offen offset:0 sc1
    buffer_load_dwordx4 v[116:119], v2, s[48:51], s76 offen offset:1024 sc1
    buffer_load_dwordx4 v[120:123], v2, s[48:51], s76 offen offset:2048 sc1
    buffer_load_dwordx4 v[124:127], v10, s[48:51], s76 offen offset:3072 sc1
    s_waitcnt vmcnt(4)
    v_xor_b32 v128, s53, v128
    v_xor_b32 v129, s53, v129
    v_xor_b32 v130, s53, v130
    v_xor_b32 v131, s53, v131
    v_xor_b32 v132, s53, v132
    v_xor_b32 v133, s53, v133
    v_xor_b32 v134, s53, v134
    v_xor_b32 v135, s53, v135
    v_xor_b32 v136, s53, v136
    v_xor_b32 v137, s53, v137
    v_xor_b32 v138, s53, v138
    v_xor_b32 v139, s53, v139
    v_xor_b32 v140, v75, v140
    v_xor_b32 v141, v75, v141
    v_xor_b32 v142, v75, v142
    v_xor_b32 v143, v75, v143
    v_or3_b32 v60, v128, v129, v130
    v_or3_b32 v60, v60, v131, v132
    v_or3_b32 v60, v60, v133, v134
    v_or3_b32 v60, v60, v135, v136
    v_or3_b32 v60, v60, v137, v138
    v_or3_b32 v60, v60, v139, v140
    v_or3_b32 v60, v60, v141, v142
    v_or_b32 v60, v60, v143
    v_and_b32 v60, 0xff, v60
    v_cmp_ne_u32 vcc, 0, v60
    v_pk_add_f32 v[128:129], v[128:129], v[132:133]
    v_pk_add_f32 v[130:131], v[130:131], v[134:135]
    v_pk_add_f32 v[136:137], v[136:137], v[140:141]
    v_pk_add_f32 v[138:139], v[138:139], v[142:143]
    v_pk_add_f32 v[88:89], v[128:129], v[136:137]
    v_pk_add_f32 v[90:91], v[130:131], v[138:139]
    s_nop 0
    v_permlane32_swap_b32 v88, v89
    v_permlane32_swap_b32 v90, v91
    v_add_f32 v88, v88, v89
    v_add_f32 v90, v90, v91
    s_nop 1
    v_permlane16_swap_b32 v88, v90
    v_add_f32 v88, v88, v90
    s_nop 1
    v_add_f32_dpp v88, v88, v88 row_ror:4 row_mask:0xf bank_mask:0xf
    s_nop 1
    v_add_f32_dpp v88, v88, v88 row_ror:8 row_mask:0xf bank_mask:0xf
    v_cvt_pk_bf16_f32 v88, 0, v88
    v_add_f32 v88, v88, v72
    v_cvt_pk_bf16_f32 v88, v88, v88
    s_cmp_lg_u64 vcc, 0
    s_cbranch_scc0 L_f1x
    buffer_load_dwordx4 v[128:131], v2, s[48:51], s76 offen offset:0 sc1
    buffer_load_dwordx4 v[132:135], v2, s[48:51], s76 offen offset:1024 sc1
    buffer_load_dwordx4 v[136:139], v2, s[48:51], s76 offen offset:2048 sc1
    buffer_load_dwordx4 v[140:143], v10, s[48:51], s76 offen offset:3072 sc1
    s_branch L_f1
L_f1x:
    s_mov_b32 exec_lo, 0x000f000f
    s_mov_b32 exec_hi, 0x000f000f
    buffer_store_short v88, v73, s[56:59], s78 offen
    s_branch L_fin
L_P:
    s_barrier
    s_lshr_b32 s76, s2, 3
    s_sub_u32 s76, s76, 18
    s_cbranch_scc1 L_fin
    s_cmp_ge_u32 s76, 64
    s_cselect_b32 s77, 10, 0
    s_sub_u32 s76, s76, s77
    s_lshl_b32 s76, s76, 3
    s_add_u32 s76, s76, s64
    s_mul_i32 s76, s76, 23
    s_and_b32 s78, s2, 7
    s_movk_i32 s77, 3456
    s_movk_i32 s79, 640
    v_lshrrev_b32 v48, 1, v1
    v_add_u32 v48, s76, v48
    v_lshrrev_b32 v49, 7, v48
    v_mul_u32_u24 v49, 52, v49
    v_lshrrev_b32 v49, 8, v49
    v_mul_u32_u24 v50, 640, v49
    v_sub_u32 v48, v48, v50
    v_lshl_add_u32 v49, v49, 3, s78
    v_cmp_gt_u32 vcc, 27, v49
    s_mov_b32 exec_lo, 0x55555555
    s_mov_b32 exec_hi, 0x1555
    s_and_b64 exec, exec, vcc
    s_cbranch_execz L_fin
    v_and_b32 v50, 1, v1
    v_lshl_add_u32 v51, v49, 1, v50
    v_lshlrev_b32 v51, 6, v51
    v_mad_u32_u24 v51, v48, s77, v51
    v_mad_u32_u24 v48, v49, s79, v48
    v_lshl_add_u32 v48, v48, 1, v50
    v_lshlrev_b32 v48, 6, v48
    global_load_dword v52, v51, s[16:17]
    global_load_dword v53, v51, s[18:19]
    buffer_load_dword v54, v48, s[60:63], 0 offen
    s_waitcnt vmcnt(0)
    s_mov_b64 exec, -1
    s_branch L_fin
    .p2align 12
L_G:
    s_barrier
    s_mul_i32 s76, s64, 160
    buffer_load_dword v95, v99, s[28:31], s76 offen
    global_load_dwordx4 v[112:115], v[208:209], off
    global_load_dwordx4 v[116:119], v[210:211], off
    global_load_dwordx4 v[120:123], v[212:213], off
    global_load_dwordx4 v[124:127], v[214:215], off
    global_load_dwordx4 v[128:131], v[216:217], off
    global_load_dwordx4 v[132:135], v[218:219], off
    global_load_dwordx4 v[136:139], v[220:221], off
    global_load_dwordx4 v[140:143], v[222:223], off
    global_load_dwordx4 v[144:147], v[224:225], off
    global_load_dwordx4 v[148:151], v[226:227], off
    v_lshrrev_b32 v10, 4, v1
    v_and_b32 v13, 15, v1
    v_mov_b32 v228, 0x01000100
    v_mov_b32 v229, 0x03020302
    v_cndmask_b32 v228, v229, v228, s[80:81]
    v_mov_b32 v229, 0x0c0c0c0c
    v_bfi_b32 v88, v6, v228, v229
    v_bfi_b32 v89, v7, v228, v229
    v_bfi_b32 v90, v8, v228, v229
    v_bfi_b32 v91, v9, v228, v229
    v_and_b32 v48, 0x3f803f80, v6
    v_and_b32 v49, 0x3f803f80, v7
    v_and_b32 v50, 0x3f803f80, v8
    v_and_b32 v51, 0x3f803f80, v9
    v_lshrrev_b32 v12, 5, v1
    v_lshl_add_u32 v84, v12, 3, s64
    v_lshlrev_b32 v84, 2, v84
    s_lshl_b32 s76, s64, 1
    v_add_u32 v12, s76, v12
    v_lshlrev_b32 v12, 8, v12
    v_and_b32 v14, 7, v1
    v_lshlrev_b32 v85, 2, v14
    v_add_u32 v85, 17408, v85
    v_lshl_add_u32 v12, v14, 5, v12
    v_bfe_u32 v15, v1, 4, 1
    v_lshl_add_u32 v12, v15, 4, v12
    v_bfe_u32 v15, v1, 3, 1
    v_lshl_add_u32 v14, v15, 5, v14
    v_lshl_add_u32 v14, v10, 3, v14
    v_lshlrev_b32 v14, 2, v14
    v_add_u32 v14, 17664, v14
    v_lshrrev_b32 v15, 1, v13
    s_lshl_b32 s76, s64, 3
    v_add_u32 v15, s76, v15
    v_mul_u32_u24 v15, 3456, v15
    v_and_b32 v13, 1, v1
    v_lshl_add_u32 v15, v13, 5, v15
    v_lshl_add_u32 v15, v10, 4, v15
    s_and_b32 s76, s2, 3
    s_mul_i32 s76, s76, 0x5000
    s_mul_i32 s77, s64, 320
    s_add_u32 s76, s76, s77
    s_add_u32 s76, s76, 1572864
    s_add_u32 s77, s76, 5120
    s_mov_b32 s84, 0x03ff03ff
    s_mov_b32 s85, 0x03ff03ff
    s_waitcnt vmcnt(0)
    v_mfma_f32_16x16x32_bf16 v[52:55], v[48:51], v[112:115], 0
    v_mfma_f32_16x16x32_bf16 v[52:55], v[48:51], v[116:119], v[52:55]
    v_mfma_f32_16x16x32_bf16 v[52:55], v[48:51], v[120:123], v[52:55]
    v_mfma_f32_16x16x32_bf16 v[52:55], v[48:51], v[124:127], v[52:55]
    v_mfma_f32_16x16x32_bf16 v[52:55], v[48:51], v[128:131], v[52:55]
    v_mfma_f32_16x16x32_bf16 v[52:55], v[48:51], v[132:135], v[52:55]
    v_mfma_f32_16x16x32_bf16 v[52:55], v[48:51], v[136:139], v[52:55]
    v_mfma_f32_16x16x32_bf16 v[52:55], v[48:51], v[140:143], v[52:55]
    v_mfma_f32_16x16x32_bf16 v[52:55], v[48:51], v[144:147], v[52:55]
    v_mfma_f32_16x16x32_bf16 v[52:55], v[48:51], v[148:151], v[52:55]
    s_mov_b32 exec_lo, 0x00ff00ff
    s_mov_b32 exec_hi, 0xff00ff00
    s_nop 5
    ds_write_b128 v12, v[52:55] offset:21760
    s_mov_b64 exec, -1
    s_waitcnt lgkmcnt(0)
    s_barrier
    ds_read2st64_b32 v[16:17], v14 offset0:16 offset1:17
    ds_read2st64_b32 v[18:19], v14 offset0:18 offset1:19
    ds_read2st64_b32 v[20:21], v14 offset0:20 offset1:21
    ds_read2st64_b32 v[22:23], v14 offset0:22 offset1:23
    ds_read2st64_b32 v[24:25], v14 offset0:24 offset1:25
    ds_read2st64_b32 v[26:27], v14 offset0:26 offset1:27
    ds_read2st64_b32 v[28:29], v14 offset0:28 offset1:29
    ds_read2st64_b32 v[30:31], v14 offset0:30 offset1:31
    s_waitcnt lgkmcnt(0)
    v_add_f32 v16, v16, v17
    v_add_f32 v18, v18, v19
    v_add_f32 v20, v20, v21
    v_add_f32 v22, v22, v23
    v_add_f32 v24, v24, v25
    v_add_f32 v26, v26, v27
    v_add_f32 v28, v28, v29
    v_add_f32 v30, v30, v31
    v_add_f32 v16, v16, v18
    v_add_f32 v20, v20, v22
    v_add_f32 v24, v24, v26
    v_add_f32 v28, v28, v30
    v_add_f32 v16, v16, v20
    v_add_f32 v24, v24, v28
    v_add_f32 v16, v16, v24
    v_mov_b32 v86, v16
    v_lshlrev_b32 v228, 16, v95
    v_and_b32 v229, s89, v95
    v_not_b32 v192, s52
    s_mov_b32 s86, 0
    buffer_load_dwordx4 v[176:179], v102, s[48:51], s76 offen offset:0 sc1
    buffer_load_dwordx4 v[180:183], v102, s[48:51], s76 offen offset:2560 sc1
    buffer_load_dwordx4 v[184:187], v102, s[48:51], s77 offen offset:0 sc1
    buffer_load_dwordx4 v[188:191], v102, s[48:51], s77 offen offset:2560 sc1
    buffer_load_dwordx4 v[152:155], v96, s[60:63], s42 offen offset:0
    buffer_load_dwordx4 v[156:159], v96, s[60:63], s42 offen offset:1280
    buffer_load_dwordx4 v[160:163], v96, s[60:63], s42 offen offset:2560
    buffer_load_dwordx4 v[164:167], v96, s[60:63], s42 offen offset:3840
    buffer_load_dwordx4 v[168:171], v96, s[60:63], s43 offen offset:0
    buffer_load_dwordx4 v[172:175], v96, s[60:63], s43 offen offset:1280
    buffer_load_dwordx4 v[104:107], v96, s[60:63], s43 offen offset:2560
    buffer_load_dwordx4 v[108:111], v96, s[60:63], s43 offen offset:3840
    s_waitcnt vmcnt(8)
    v_xor_b32 v176, s53, v176
    v_xor_b32 v177, s53, v177
    v_xor_b32 v178, s53, v178
    v_xor_b32 v179, s53, v179
    v_xor_b32 v180, s53, v180
    v_xor_b32 v181, s53, v181
    v_xor_b32 v182, s53, v182
    v_xor_b32 v183, s53, v183
    v_xor_b32 v184, s53, v184
    v_xor_b32 v185, s53, v185
    v_xor_b32 v186, s53, v186
    v_xor_b32 v187, s53, v187
    v_xor_b32 v188, s53, v188
    v_xor_b32 v189, s53, v189
    v_xor_b32 v190, s53, v190
    v_xor_b32 v191, s53, v191
    v_or3_b32 v238, v176, v177, v178
    v_or3_b32 v238, v238, v179, v180
    v_or3_b32 v238, v238, v181, v182
    v_or3_b32 v238, v238, v183, v184
    v_or3_b32 v238, v238, v185, v186
    v_or3_b32 v238, v238, v187, v188
    v_or3_b32 v238, v238, v189, v190
    v_or_b32 v238, v238, v191
    v_and_b32 v238, 0xff, v238
    v_cmp_ne_u32 vcc, 0, v238
    v_pk_add_f32 v[176:177], v[176:177], v[180:181]
    v_pk_add_f32 v[178:179], v[178:179], v[182:183]
    v_pk_add_f32 v[184:185], v[184:185], v[188:189]
    v_pk_add_f32 v[186:187], v[186:187], v[190:191]
    v_pk_add_f32 v[176:177], v[176:177], v[184:185]
    v_pk_add_f32 v[178:179], v[178:179], v[186:187]
    s_nop 1
    v_permlane32_swap_b32 v176, v178
    v_permlane32_swap_b32 v177, v179
    v_pk_add_f32 v[176:177], v[176:177], v[178:179]
    v_cvt_pk_bf16_f32 v176, v176, v177
    v_and_b32 v177, s89, v176
    v_lshlrev_b32 v176, 16, v176
    v_pk_add_f32 v[176:177], v[176:177], v[228:229]
    v_cvt_pk_bf16_f32 v94, v176, v177
    s_cmp_lg_u64 vcc, 0
    s_cbranch_scc0 L_g2x
    s_mov_b32 s86, 0
L_g2:
    s_add_u32 s86, s86, 1
    s_cmp_gt_u32 s86, 65536
    s_cbranch_scc1 L_g2x
    buffer_load_dwordx4 v[176:179], v102, s[48:51], s76 offen offset:0 sc1
    buffer_load_dwordx4 v[180:183], v102, s[48:51], s76 offen offset:2560 sc1
    buffer_load_dwordx4 v[184:187], v102, s[48:51], s77 offen offset:0 sc1
    buffer_load_dwordx4 v[188:191], v102, s[48:51], s77 offen offset:2560 sc1
    s_waitcnt vmcnt(4)
    v_xor_b32 v192, s53, v192
    v_xor_b32 v193, s53, v193
    v_xor_b32 v194, s53, v194
    v_xor_b32 v195, s53, v195
    v_xor_b32 v196, s53, v196
    v_xor_b32 v197, s53, v197
    v_xor_b32 v198, s53, v198
    v_xor_b32 v199, s53, v199
    v_xor_b32 v200, s53, v200
    v_xor_b32 v201, s53, v201
    v_xor_b32 v202, s53, v202
    v_xor_b32 v203, s53, v203
    v_xor_b32 v204, s53, v204
    v_xor_b32 v205, s53, v205
    v_xor_b32 v206, s53, v206
    v_xor_b32 v207, s53, v207
    v_or3_b32 v238, v192, v193, v194
    v_or3_b32 v238, v238, v195, v196
    v_or3_b32 v238, v238, v197, v198
    v_or3_b32 v238, v238, v199, v200
    v_or3_b32 v238, v238, v201, v202
    v_or3_b32 v238, v238, v203, v204
    v_or3_b32 v238, v238, v205, v206
    v_or_b32 v238, v238, v207
    v_and_b32 v238, 0xff, v238
    v_cmp_ne_u32 vcc, 0, v238
    v_pk_add_f32 v[192:193], v[192:193], v[196:197]
    v_pk_add_f32 v[194:195], v[194:195], v[198:199]
    v_pk_add_f32 v[200:201], v[200:201], v[204:205]
    v_pk_add_f32 v[202:203], v[202:203], v[206:207]
    v_pk_add_f32 v[192:193], v[192:193], v[200:201]
    v_pk_add_f32 v[194:195], v[194:195], v[202:203]
    s_nop 1
    v_permlane32_swap_b32 v192, v194
    v_permlane32_swap_b32 v193, v195
    v_pk_add_f32 v[192:193], v[192:193], v[194:195]
    v_cvt_pk_bf16_f32 v192, v192, v193
    v_and_b32 v193, s89, v192
    v_lshlrev_b32 v192, 16, v192
    v_pk_add_f32 v[192:193], v[192:193], v[228:229]
    v_cvt_pk_bf16_f32 v94, v192, v193
    s_cmp_lg_u64 vcc, 0
    s_cbranch_scc0 L_g2x
    buffer_load_dwordx4 v[192:195], v102, s[48:51], s76 offen offset:0 sc1
    buffer_load_dwordx4 v[196:199], v102, s[48:51], s76 offen offset:2560 sc1
    buffer_load_dwordx4 v[200:203], v102, s[48:51], s77 offen offset:0 sc1
    buffer_load_dwordx4 v[204:207], v102, s[48:51], s77 offen offset:2560 sc1
    s_waitcnt vmcnt(4)
    v_xor_b32 v176, s53, v176
    v_xor_b32 v177, s53, v177
    v_xor_b32 v178, s53, v178
    v_xor_b32 v179, s53, v179
    v_xor_b32 v180, s53, v180
    v_xor_b32 v181, s53, v181
    v_xor_b32 v182, s53, v182
    v_xor_b32 v183, s53, v183
    v_xor_b32 v184, s53, v184
    v_xor_b32 v185, s53, v185
    v_xor_b32 v186, s53, v186
    v_xor_b32 v187, s53, v187
    v_xor_b32 v188, s53, v188
    v_xor_b32 v189, s53, v189
    v_xor_b32 v190, s53, v190
    v_xor_b32 v191, s53, v191
    v_or3_b32 v238, v176, v177, v178
    v_or3_b32 v238, v238, v179, v180
    v_or3_b32 v238, v238, v181, v182
    v_or3_b32 v238, v238, v183, v184
    v_or3_b32 v238, v238, v185, v186
    v_or3_b32 v238, v238, v187, v188
    v_or3_b32 v238, v238, v189, v190
    v_or_b32 v238, v238, v191
    v_and_b32 v238, 0xff, v238
    v_cmp_ne_u32 vcc, 0, v238
    v_pk_add_f32 v[176:177], v[176:177], v[180:181]
    v_pk_add_f32 v[178:179], v[178:179], v[182:183]
    v_pk_add_f32 v[184:185], v[184:185], v[188:189]
    v_pk_add_f32 v[186:187], v[186:187], v[190:191]
    v_pk_add_f32 v[176:177], v[176:177], v[184:185]
    v_pk_add_f32 v[178:179], v[178:179], v[186:187]
    s_nop 1
    v_permlane32_swap_b32 v176, v178
    v_permlane32_swap_b32 v177, v179
    v_pk_add_f32 v[176:177], v[176:177], v[178:179]
    v_cvt_pk_bf16_f32 v176, v176, v177
    v_and_b32 v177, s89, v176
    v_lshlrev_b32 v176, 16, v176
    v_pk_add_f32 v[176:177], v[176:177], v[228:229]
    v_cvt_pk_bf16_f32 v94, v176, v177
    s_cmp_lg_u64 vcc, 0
    s_cbranch_scc1 L_g2
L_g2x:
    v_mov_b32_dpp v92, v94 row_newbcast:0 row_mask:0xf bank_mask:0xf
    v_mov_b32_dpp v93, v94 row_newbcast:1 row_mask:0xf bank_mask:0xf
    v_perm_b32 v56, v92, v92, v88
    v_perm_b32 v57, v92, v92, v89
    v_perm_b32 v58, v92, v92, v90
    v_perm_b32 v59, v92, v92, v91
    v_perm_b32 v60, v93, v93, v88
    v_perm_b32 v61, v93, v93, v89
    v_perm_b32 v62, v93, v93, v90
    v_perm_b32 v63, v93, v93, v91
    v_mov_b32_dpp v92, v94 row_newbcast:2 row_mask:0xf bank_mask:0xf
    v_mfma_f32_16x16x32_bf16 v[52:55], v[56:59], v[112:115], 0
    v_cndmask_b32 v231, 0, v94, s[84:85]
    v_lshlrev_b32 v230, 16, v231
    v_perm_b32 v64, v92, v92, v88
    v_perm_b32 v65, v92, v92, v89
    v_perm_b32 v66, v92, v92, v90
    v_perm_b32 v67, v92, v92, v91
    v_mov_b32_dpp v93, v94 row_newbcast:3 row_mask:0xf bank_mask:0xf
    v_mfma_f32_16x16x32_bf16 v[52:55], v[60:63], v[116:119], v[52:55]
    v_and_b32 v231, s89, v231
    v_mul_f32 v236, v230, v230
    v_perm_b32 v56, v93, v93, v88
    v_perm_b32 v57, v93, v93, v89
    v_perm_b32 v58, v93, v93, v90
    v_perm_b32 v59, v93, v93, v91
    v_mov_b32_dpp v92, v94 row_newbcast:4 row_mask:0xf bank_mask:0xf
    v_mfma_f32_16x16x32_bf16 v[52:55], v[64:67], v[120:123], v[52:55]
    v_add_f32 v234, v230, v231
    v_fmac_f32 v236, v231, v231
    v_perm_b32 v60, v92, v92, v88
    v_perm_b32 v61, v92, v92, v89
    v_perm_b32 v62, v92, v92, v90
    v_perm_b32 v63, v92, v92, v91
    v_mov_b32_dpp v93, v94 row_newbcast:5 row_mask:0xf bank_mask:0xf
    v_mfma_f32_16x16x32_bf16 v[52:55], v[56:59], v[124:127], v[52:55]
    v_permlane32_swap_b32 v234, v236
    v_perm_b32 v64, v93, v93, v88
    v_perm_b32 v65, v93, v93, v89
    v_perm_b32 v66, v93, v93, v90
    v_perm_b32 v67, v93, v93, v91
    v_mov_b32_dpp v92, v94 row_newbcast:6 row_mask:0xf bank_mask:0xf
    v_mfma_f32_16x16x32_bf16 v[52:55], v[60:63], v[128:131], v[52:55]
    v_add_f32 v234, v234, v236
    v_mov_b32 v236, v234
    v_perm_b32 v56, v92, v92, v88
    v_perm_b32 v57, v92, v92, v89
    v_perm_b32 v58, v92, v92, v90
    v_perm_b32 v59, v92, v92, v91
    v_mov_b32_dpp v93, v94 row_newbcast:7 row_mask:0xf bank_mask:0xf
    v_mfma_f32_16x16x32_bf16 v[52:55], v[64:67], v[132:135], v[52:55]
    v_permlane16_swap_b32 v234, v236
    v_perm_b32 v60, v93, v93, v88
    v_perm_b32 v61, v93, v93, v89
    v_perm_b32 v62, v93, v93, v90
    v_perm_b32 v63, v93, v93, v91
    v_mov_b32_dpp v92, v94 row_newbcast:8 row_mask:0xf bank_mask:0xf
    v_mfma_f32_16x16x32_bf16 v[52:55], v[56:59], v[136:139], v[52:55]
    v_add_f32 v234, v234, v236
    v_perm_b32 v64, v92, v92, v88
    v_perm_b32 v65, v92, v92, v89
    v_perm_b32 v66, v92, v92, v90
    v_perm_b32 v67, v92, v92, v91
    v_mov_b32_dpp v93, v94 row_newbcast:9 row_mask:0xf bank_mask:0xf
    v_mfma_f32_16x16x32_bf16 v[52:55], v[60:63], v[140:143], v[52:55]
    v_add_f32_dpp v234, v234, v234 row_ror:8 row_mask:0xf bank_mask:0xf
    v_perm_b32 v56, v93, v93, v88
    v_perm_b32 v57, v93, v93, v89
    v_perm_b32 v58, v93, v93, v90
    v_perm_b32 v59, v93, v93, v91
    v_mfma_f32_16x16x32_bf16 v[52:55], v[64:67], v[144:147], v[52:55]
    v_add_f32_dpp v234, v234, v234 row_ror:4 row_mask:0xf bank_mask:0xf
    v_mfma_f32_16x16x32_bf16 v[52:55], v[56:59], v[148:151], v[52:55]
    s_nop 0
    v_add_f32_dpp v234, v234, v234 row_ror:2 row_mask:0xf bank_mask:0xf
    s_nop 1
    v_add_f32_dpp v234, v234, v234 row_ror:1 row_mask:0xf bank_mask:0xf
    s_mov_b32 exec_lo, 1
    s_mov_b32 exec_hi, 1
    ds_write_b32 v84, v234 offset:17408
    s_mov_b32 exec_lo, 0x00ff00ff
    s_mov_b32 exec_hi, 0xff00ff00
    ds_write_b128 v12, v[52:55] offset:17664
    s_mov_b64 exec, -1
    s_waitcnt lgkmcnt(0)
    s_barrier
    s_cmp_ge_u32 s64, 5
    s_cbranch_scc1 L_fin
    ds_read2_b32 v[234:235], v85 offset0:0 offset1:8
    ds_read2st64_b32 v[16:17], v14 offset0:0 offset1:1
    ds_read2st64_b32 v[18:19], v14 offset0:2 offset1:3
    ds_read2st64_b32 v[20:21], v14 offset0:4 offset1:5
    ds_read2st64_b32 v[22:23], v14 offset0:6 offset1:7
    ds_read2st64_b32 v[24:25], v14 offset0:8 offset1:9
    ds_read2st64_b32 v[26:27], v14 offset0:10 offset1:11
    ds_read2st64_b32 v[28:29], v14 offset0:12 offset1:13
    ds_read2st64_b32 v[30:31], v14 offset0:14 offset1:15
    s_lshl_b32 s76, s69, 6
    s_add_u32 s76, s76, 1769472
    s_mov_b32 s77, 0x3d372713
    s_mov_b32 s78, 0xc0135761
    s_waitcnt lgkmcnt(8)
    v_add_f32_dpp v234, v234, v234 row_half_mirror row_mask:0xf bank_mask:0xf
    v_add_f32_dpp v235, v235, v235 row_half_mirror row_mask:0xf bank_mask:0xf
    s_nop 0
    v_add_f32_dpp v234, v234, v234 quad_perm:[2,3,0,1] row_mask:0xf bank_mask:0xf
    v_add_f32_dpp v235, v235, v235 quad_perm:[2,3,0,1] row_mask:0xf bank_mask:0xf
    s_nop 0
    v_add_f32_dpp v234, v234, v234 quad_perm:[1,0,3,2] row_mask:0xf bank_mask:0xf
    v_add_f32_dpp v235, v235, v235 quad_perm:[1,0,3,2] row_mask:0xf bank_mask:0xf
    v_mul_f32 v234, 0x3acccccd, v234
    v_mul_f32 v235, 0x3acccccd, v235
    v_fma_f32 v235, -v234, v234, v235
    v_max_f32 v235, 0, v235
    s_waitcnt lgkmcnt(0)
    v_pk_add_f32 v[16:17], v[16:17], v[18:19]
    v_cvt_pk_bf16_f32 v235, 0, v235
    v_pk_add_f32 v[20:21], v[20:21], v[22:23]
    v_add_f32 v235, 0x3727c5ac, v235
    v_pk_add_f32 v[24:25], v[24:25], v[26:27]
    v_cvt_pk_bf16_f32 v235, 0, v235
    v_pk_add_f32 v[28:29], v[28:29], v[30:31]
    v_sqrt_f32 v235, v235
    v_pk_add_f32 v[16:17], v[16:17], v[20:21]
    v_cvt_pk_bf16_f32 v234, 0, v234
    v_pk_add_f32 v[24:25], v[24:25], v[28:29]
    v_cvt_pk_bf16_f32 v235, 0, v235
    v_pk_add_f32 v[16:17], v[16:17], v[24:25]
    v_rcp_f32 v235, v235
    v_add_f32 v16, v16, v17
    v_fma_f32 v16, -v234, v86, v16
    v_mul_f32 v16, v16, v235
    v_cvt_pk_bf16_f32 v16, 0, v16
    v_mul_f32 v17, v16, v16
    s_nop 0
    v_mov_b32_dpp v19, v16 row_ror:8 row_mask:0xf bank_mask:0xf
    v_mul_f32 v17, v17, v16
    v_fma_f32 v17, v17, s77, v16
    v_mul_f32 v17, s78, v17
    v_exp_f32 v17, v17
    v_mov_b32 v18, s53
    v_add_f32 v17, 1.0, v17
    v_rcp_f32 v17, v17
    s_nop 0
    v_mul_f32 v17, v17, v16
    v_cvt_pk_bf16_f32 v17, 0, v17
    v_mul_f32 v17, v17, v19
    v_cvt_pk_bf16_f32 v17, v17, v17
    s_nop 1
    v_and_b32_dpp v56, v17, v6 row_newbcast:0 row_mask:0xf bank_mask:0xf
    v_and_b32_dpp v57, v17, v7 row_newbcast:0 row_mask:0xf bank_mask:0xf
    v_and_b32_dpp v58, v17, v8 row_newbcast:0 row_mask:0xf bank_mask:0xf
    v_and_b32_dpp v59, v17, v9 row_newbcast:0 row_mask:0xf bank_mask:0xf
    s_cmp_lg_u32 s86, 0
    s_cbranch_scc1 L_dok
    s_waitcnt vmcnt(0)
L_dok:
    v_and_b32_dpp v60, v17, v6 row_newbcast:1 row_mask:0xf bank_mask:0xf
    v_and_b32_dpp v61, v17, v7 row_newbcast:1 row_mask:0xf bank_mask:0xf
    v_and_b32_dpp v62, v17, v8 row_newbcast:1 row_mask:0xf bank_mask:0xf
    v_and_b32_dpp v63, v17, v9 row_newbcast:1 row_mask:0xf bank_mask:0xf
    v_mfma_f32_16x16x32_bf16 v[52:55], v[56:59], v[152:155], 0
    v_and_b32_dpp v64, v17, v6 row_newbcast:2 row_mask:0xf bank_mask:0xf
    v_and_b32_dpp v65, v17, v7 row_newbcast:2 row_mask:0xf bank_mask:0xf
    v_and_b32_dpp v66, v17, v8 row_newbcast:2 row_mask:0xf bank_mask:0xf
    v_and_b32_dpp v67, v17, v9 row_newbcast:2 row_mask:0xf bank_mask:0xf
    v_mfma_f32_16x16x32_bf16 v[52:55], v[60:63], v[156:159], v[52:55]
    v_and_b32_dpp v56, v17, v6 row_newbcast:3 row_mask:0xf bank_mask:0xf
    v_and_b32_dpp v57, v17, v7 row_newbcast:3 row_mask:0xf bank_mask:0xf
    v_and_b32_dpp v58, v17, v8 row_newbcast:3 row_mask:0xf bank_mask:0xf
    v_and_b32_dpp v59, v17, v9 row_newbcast:3 row_mask:0xf bank_mask:0xf
    v_mfma_f32_16x16x32_bf16 v[52:55], v[64:67], v[160:163], v[52:55]
    v_and_b32_dpp v60, v17, v6 row_newbcast:4 row_mask:0xf bank_mask:0xf
    v_and_b32_dpp v61, v17, v7 row_newbcast:4 row_mask:0xf bank_mask:0xf
    v_and_b32_dpp v62, v17, v8 row_newbcast:4 row_mask:0xf bank_mask:0xf
    v_and_b32_dpp v63, v17, v9 row_newbcast:4 row_mask:0xf bank_mask:0xf
    v_mfma_f32_16x16x32_bf16 v[52:55], v[56:59], v[164:167], v[52:55]
    v_and_b32_dpp v64, v17, v6 row_newbcast:5 row_mask:0xf bank_mask:0xf
    v_and_b32_dpp v65, v17, v7 row_newbcast:5 row_mask:0xf bank_mask:0xf
    v_and_b32_dpp v66, v17, v8 row_newbcast:5 row_mask:0xf bank_mask:0xf
    v_and_b32_dpp v67, v17, v9 row_newbcast:5 row_mask:0xf bank_mask:0xf
    v_mfma_f32_16x16x32_bf16 v[52:55], v[60:63], v[168:171], v[52:55]
    v_and_b32_dpp v56, v17, v6 row_newbcast:6 row_mask:0xf bank_mask:0xf
    v_and_b32_dpp v57, v17, v7 row_newbcast:6 row_mask:0xf bank_mask:0xf
    v_and_b32_dpp v58, v17, v8 row_newbcast:6 row_mask:0xf bank_mask:0xf
    v_and_b32_dpp v59, v17, v9 row_newbcast:6 row_mask:0xf bank_mask:0xf
    v_mfma_f32_16x16x32_bf16 v[52:55], v[64:67], v[172:175], v[52:55]
    v_and_b32_dpp v60, v17, v6 row_newbcast:7 row_mask:0xf bank_mask:0xf
    v_and_b32_dpp v61, v17, v7 row_newbcast:7 row_mask:0xf bank_mask:0xf
    v_and_b32_dpp v62, v17, v8 row_newbcast:7 row_mask:0xf bank_mask:0xf
    v_and_b32_dpp v63, v17, v9 row_newbcast:7 row_mask:0xf bank_mask:0xf
    v_mfma_f32_16x16x32_bf16 v[52:55], v[56:59], v[104:107], v[52:55]
    s_nop 0
    v_mfma_f32_16x16x32_bf16 v[52:55], v[60:63], v[108:111], v[52:55]
    s_nop 7
    v_and_or_b32 v52, v52, s3, v18
    v_and_or_b32 v53, v53, s3, v18
    v_and_or_b32 v54, v54, s3, v18
    v_and_or_b32 v55, v55, s3, v18
    s_mov_b64 exec, s[82:83]
    buffer_store_dwordx4 v[52:55], v15, s[48:51], s76 offen sc1
L_fin:
L_end:
    s_endpgm
.section .rodata,"a"
.p2align 6
.amdhsa_kernel sequential_preLN__gqa_block_cached__glu_gated_geglu__decode_kernel
  .amdhsa_next_free_vgpr 256
  .amdhsa_next_free_sgpr 102
  .amdhsa_accum_offset 256
  .amdhsa_group_segment_fixed_size 0
  .amdhsa_kernarg_size 96
  .amdhsa_user_sgpr_count 2
  .amdhsa_user_sgpr_kernarg_segment_ptr 1
  .amdhsa_system_sgpr_workgroup_id_x 1
  .amdhsa_float_denorm_mode_32 3
.end_amdhsa_kernel
```
